```python
import torch

def _softmax(x, axis=-1):
    return torch.softmax(x, dim=axis)
def _gelu(x):
    return torch.nn.functional.gelu(x, approximate="tanh")
def _silu(x):
    return torch.nn.functional.silu(x)
def _sigmoid(x):
    return torch.sigmoid(x)
def _layernorm(x, axis=-1, eps=1e-5):
    m = x.mean(dim=axis, keepdim=True)
    v = x.var(dim=axis, keepdim=True, unbiased=False)
    return (x - m) / torch.sqrt(v + eps)
def _scatter_add(tgt, idx, src, axis=0):
    return tgt.clone().index_add_(axis, idx, src)
def _segment_sum(src, seg, n):
    out = torch.zeros((n,) + src.shape[1:], dtype=src.dtype)
    return out.index_add_(0, seg, src)
def _pad(x, pw):
    flat = tuple(v for pair in reversed(pw) for v in pair)
    return torch.nn.functional.pad(x, flat)

kernel_name = 'parallel_sum__ssm_conv_s4__glu_gated_geglu__prompt'

def setup_inputs():

    _w = (lambda a: (lambda t: t.to(torch.bfloat16) if t.is_floating_point() else t)(torch.as_tensor(a)))
    def _A_setup():
        B, L, D, N = 1, 2048, 512, 128
        A_re = -(lambda _x: torch.exp(torch.as_tensor(_x)))((lambda *s: torch.randn(*s, dtype=torch.bfloat16) * 6.4)(D, N))
        A_im = torch.pi * (lambda *s: torch.randn(*s, dtype=torch.bfloat16) * 0.05)(D, N)
        B_re = (lambda *s: torch.randn(*s, dtype=torch.bfloat16) * 0.1)(D, N)
        B_im = (lambda *s: torch.randn(*s, dtype=torch.bfloat16) * 0.1)(D, N)
        C_re = (lambda *s: torch.randn(*s, dtype=torch.bfloat16) * 0.1)(D, N)
        C_im = (lambda *s: torch.randn(*s, dtype=torch.bfloat16) * 0.1)(D, N)
        log_dt = (lambda *s: torch.randn(*s, dtype=torch.bfloat16) * 0.05)(D) * 0.5 - 4.0
        Dskip = (lambda *s: torch.randn(*s, dtype=torch.bfloat16) * 0.05)(D)
        return {
            "u": _w((lambda *s: torch.randn(*s, dtype=torch.bfloat16) * 0.05)(B, L, D)),
            "A_re": _w(A_re),
            "A_im": _w(A_im),
            "B_re": _w(B_re),
            "B_im": _w(B_im),
            "C_re": _w(C_re),
            "C_im": _w(C_im),
            "log_dt": _w(log_dt),
            "Dskip": _w(Dskip),
        }
    _A_in = _A_setup()

    def _B_setup():
        B, S, Dm, Df = 1, 2048, 512, 1792
        return {
            "x": _w((lambda *s: torch.randn(*s, dtype=torch.bfloat16) * 0.05)(B, S, Dm)),
            "w_gate": _w((lambda *s: torch.randn(*s, dtype=torch.bfloat16) * 0.4)(Dm, Df) * (Dm ** -0.5)),
            "w_up": _w((lambda *s: torch.randn(*s, dtype=torch.bfloat16) * 0.4)(Dm, Df) * (Dm ** -0.5)),
            "w_down": _w((lambda *s: torch.randn(*s, dtype=torch.bfloat16) * 0.4)(Df, Dm) * (Df ** -0.5)),
        }
    _B_in = _B_setup()

    return {
        "A_u": _A_in["u"],
        "A_A_re": _A_in["A_re"],
        "A_A_im": _A_in["A_im"],
        "A_B_re": _A_in["B_re"],
        "A_B_im": _A_in["B_im"],
        "A_C_re": _A_in["C_re"],
        "A_C_im": _A_in["C_im"],
        "A_log_dt": _A_in["log_dt"],
        "A_Dskip": _A_in["Dskip"],
        "B_x": _B_in["x"],
        "B_w_gate": _B_in["w_gate"],
        "B_w_up": _B_in["w_up"],
        "B_w_down": _B_in["w_down"],
    }

def reference(A_u, A_A_re, A_A_im, A_B_re, A_B_im, A_C_re, A_C_im, A_log_dt, A_Dskip, B_x, B_w_gate, B_w_up, B_w_down):
    def _A_ref(u, A_re, A_im, B_re, B_im, C_re, C_im, log_dt, Dskip):
        Bsz, L, D = u.shape
        dt = torch.exp(log_dt)[:, None]
        A = A_re + 1j * A_im
        Bc = B_re + 1j * B_im
        Cc = C_re + 1j * C_im
        logdA = dt * A
        dB = dt * Bc
        l = (lambda x, dt: x.to(dt))(torch.arange(L), A_re.dtype)
        P = torch.exp(logdA[:, :, None] * l[None, None, :])
        K = torch.einsum("dn,dnl,dn->dl", Cc, P, dB).real
        L2 = 2 * L
        Kp = _pad(K, ((0, 0), (0, L)))
        up = (lambda x, *d: x.permute(*d))(u, 0, 2, 1)
        up = _pad(up, ((0, 0), (0, 0), (0, L)))
        Kf = (lambda x, axes=(-2,-1): torch.fft.rfft2(x.float(), dim=axes))(Kp[:, None, :], axes=(-2, -1))
        Uf = (lambda x, axes=(-2,-1): torch.fft.rfft2(x.float(), dim=axes))(up[:, :, None, :], axes=(-2, -1))
        Yf = Uf * Kf[None, :, :, :]
        y = (lambda x, s, axes=(-2,-1): torch.fft.irfft2(x, s=s, dim=axes).to(torch.bfloat16))(Yf, (1, L2), axes=(-2, -1))[:, :, 0, :L]
        y = (lambda x, *d: x.permute(*d))(y, 0, 2, 1) + u * Dskip[None, None, :]
        return y

    def _B_ref(x, w_gate, w_up, w_down):
        g = torch.einsum("bsd,df->bsf", x, w_gate)
        u = torch.einsum("bsd,df->bsf", x, w_up)
        h = _gelu(g) * u
        return torch.einsum("bsf,fd->bsd", h, w_down)

    x = A_u
    xn = _layernorm(x, axis=-1)
    return x + _A_ref(xn, A_A_re, A_A_im, A_B_re, A_B_im, A_C_re, A_C_im, A_log_dt, A_Dskip) + _B_ref(xn, B_w_gate, B_w_up, B_w_down)
```

```asm
; @launch grid=(256,1,1) block=(256,1,1) lds=163840
.amdgcn_target "amdgcn-amd-amdhsa--gfx950"
.text
.globl parallel_sum__ssm_conv_s4__glu_gated_geglu__prompt_kernel
.p2align 8
.type parallel_sum__ssm_conv_s4__glu_gated_geglu__prompt_kernel,@function
parallel_sum__ssm_conv_s4__glu_gated_geglu__prompt_kernel:
    s_cmp_ge_u32 s2, 256
    s_cbranch_scc1 L_end
    s_load_dwordx16 s[4:19], s[0:1], 0
    v_lshrrev_b32 v5, 5, v0
    v_and_b32 v6, 31, v0
    v_lshlrev_b32 v7, 10, v5
    v_lshl_add_u32 v7, v6, 4, v7
    s_lshl_b32 s72, s2, 13
    s_mov_b32 s38, 2097152
    s_mov_b32 s39, 0x20000
    s_getpc_b64 s[96:97]
    s_lshr_b32 s3, s2, 3
    s_min_u32 s3, s3, 22
    s_lshl_b32 s3, s3, 10
    s_add_u32 s96, s96, s3
    s_addc_u32 s97, s97, 0
    v_lshlrev_b32 v254, 2, v0
    v_mov_b32 v255, s97
    v_add_co_u32 v254, vcc, s96, v254
    s_load_dwordx4 s[20:23], s[0:1], 64
    s_load_dwordx8 s[24:31], s[0:1], 80
    v_addc_co_u32 v255, vcc, 0, v255, vcc
    global_load_dword v111, v[254:255], off
    s_load_dwordx2 s[32:33], s[0:1], 120
    v_lshrrev_b32 v2, 6, v0
    v_and_b32 v1, 63, v0
    v_readfirstlane_b32 s60, v2
    s_waitcnt lgkmcnt(0)
    s_mov_b32 s36, s4
    s_and_b32 s37, s5, 0xffff
    buffer_load_dwordx4 v[8:11], v7, s[36:39], s72 offen
    buffer_load_dwordx4 v[12:15], v7, s[36:39], s72 offen offset:512
    s_and_b32 s61, s2, 7
    s_lshr_b32 s62, s2, 3
    s_lshl_b32 s70, s61, 5
    s_add_u32 s63, s70, s62
    s_and_b32 s67, s62, 7
    s_lshr_b32 s70, s61, 2
    s_lshl_b32 s70, s70, 3
    s_lshr_b32 s71, s62, 2
    s_add_u32 s64, s70, s71
    s_and_b32 s70, s61, 3
    s_lshl_b32 s70, s70, 2
    s_and_b32 s71, s62, 3
    s_add_u32 s65, s70, s71
    s_lshr_b32 s71, s62, 3
    s_lshl_b32 s70, s61, 2
    s_add_u32 s66, s70, s71
    s_and_b32 s81, s60, 1
    s_lshr_b32 s82, s60, 1
    s_mov_b32 s78, 0xffff0000
    v_lshlrev_b32 v2, 4, v1
    s_mov_b32 s40, s32
    s_and_b32 s41, s33, 0xffff
    s_mov_b32 s42, 67108864
    s_mov_b32 s43, 0x20000
    v_mov_b32 v3, 0
    buffer_load_dword v4, v3, s[40:43], 0 offen sc0 sc1
    s_lshl_b32 s70, s63, 1
    s_add_u32 s70, s70, s82
    s_lshl_b32 s70, s70, 8
    s_lshl_b32 s71, s81, 7
    s_add_u32 s70, s70, s71
    v_lshl_add_u32 v6, v1, 1, s70
    global_load_ushort v16, v6, s[6:7]
    global_load_ushort v17, v6, s[8:9]
    global_load_ushort v18, v6, s[10:11]
    global_load_ushort v19, v6, s[12:13]
    global_load_ushort v20, v6, s[14:15]
    global_load_ushort v21, v6, s[16:17]
    s_lshl_b32 s70, s63, 2
    s_load_dword s76, s[18:19], s70
    s_load_dword s77, s[20:21], s70
    s_cmp_ge_u32 s60, 2
    s_cselect_b32 s44, s26, s24
    s_cselect_b32 s45, s27, s25
    s_and_b32 s45, s45, 0xffff
    s_mov_b32 s46, 1835008
    s_mov_b32 s47, 0x20000
    s_mov_b32 s52, s28
    s_and_b32 s53, s29, 0xffff
    s_mov_b32 s54, 1835008
    s_mov_b32 s55, 0x20000
    s_mov_b32 s56, s30
    s_and_b32 s57, s31, 0xffff
    s_mov_b32 s58, 2097152
    s_mov_b32 s59, 0x20000
    s_cmp_eq_u32 s60, 0
    s_cselect_b32 s69, 0, 0x7ff00000
    v_lshrrev_b32 v27, 3, v1
    v_and_b32_e64 v28, 7, v1
    v_bfe_u32 v29, v27, 1, 1
    v_lshlrev_b32 v29, 2, v29
    v_xor_b32 v30, v28, v29
    v_lshlrev_b32_e64 v31, 10, v27
    v_lshl_add_u32 v26, v30, 4, v31
    s_lshl_b32 s70, s82, 1
    v_xor_b32 v30, s70, v30
    s_movk_i32 s71, 3584
    v_mul_u32_u24 v31, s71, v27
    v_lshl_add_u32 v22, v30, 4, v31
    s_lshl_b32 s79, s82, 13
    s_lshl_b32 s70, s81, 12
    s_add_u32 s79, s79, s70
    s_mul_i32 s80, s81, 114688
    s_lshl_b32 s70, s65, 7
    s_add_u32 s80, s80, s70
    s_lshl_b32 s70, s65, 5
    s_sub_u32 s35, 2048, s70
    s_and_b32 s70, s62, 3
    s_lshl_b32 s70, s70, 1
    s_lshr_b32 s71, s62, 2
    s_add_u32 s71, s71, s70
    s_mov_b32 s101, s71
    s_add_u32 s72, s101, 0
    s_and_b32 s72, s72, 7
    s_mul_i32 s72, s72, 229376
    s_add_u32 s4, s72, s80
    s_add_u32 m0, s79, 0
    s_add_u32 s34, s4, 0
    buffer_load_dwordx4 v22, s[44:47], s34 offen lds
    s_add_u32 m0, s79, 1024
    s_add_u32 s34, s4, 28672
    buffer_load_dwordx4 v22, s[44:47], s34 offen lds
    s_add_u32 m0, s79, 2048
    s_add_u32 s34, s4, 57344
    buffer_load_dwordx4 v22, s[44:47], s34 offen lds
    s_add_u32 m0, s79, 3072
    s_add_u32 s34, s4, 86016
    buffer_load_dwordx4 v22, s[44:47], s34 offen lds
    s_movk_i32 s72, 10923
    s_movk_i32 s73, 3488
    v_add_u32 v27, 0, v1
    v_mul_u32_u24 v28, s72, v27
    v_lshrrev_b32 v28, 16, v28
    v_lshlrev_b32 v27, 4, v27
    v_mad_u32_u24 v23, v28, s73, v27
    v_add_u32 v27, 64, v1
    v_mul_u32_u24 v28, s72, v27
    v_lshrrev_b32 v28, 16, v28
    v_lshlrev_b32 v27, 4, v27
    v_mad_u32_u24 v24, v28, s73, v27
    v_add_u32 v27, 128, v1
    v_mul_u32_u24 v28, s72, v27
    v_lshrrev_b32 v28, 16, v28
    v_lshlrev_b32_e64 v27, 4, v27
    v_mad_u32_u24 v25, v28, s73, v27
    s_mul_i32 s83, s82, 6272
    s_mul_i32 s70, s81, 3072
    s_add_u32 s83, s83, s70
    s_lshl_b32 s70, s64, 2
    s_add_u32 s70, s70, s60
    s_lshl_b32 s51, s70, 15
    s_add_u32 s51, s51, 1048576
    s_mul_i32 s98, s70, 114688
    s_add_u32 s98, s98, 5242880
    s_mul_i32 s71, s65, 3072
    s_add_u32 s0, s98, s71
    s_add_u32 s0, s0, 65536
    s_lshl_b32 s71, s65, 12
    s_add_u32 s98, s98, s71
    v_lshrrev_b32 v68, 5, v1
    s_lshl_b32 s70, s60, 1
    v_add_u32 v68, s70, v68
    v_mul_u32_u24 v68, 1088, v68
    v_and_b32_e64 v69, 31, v1
    v_lshl_add_u32 v68, v69, 4, v68
    v_add_u32 v64, 143936, v68
    v_and_b32 v68, 7, v0
    v_lshrrev_b32 v69, 3, v0
    v_mul_u32_u24 v70, 1088, v68
    v_lshl_add_u32 v70, v69, 4, v70
    v_add_u32 v65, 143936, v70
    v_lshrrev_b32 v70, 1, v69
    v_lshlrev_b32 v70, 10, v70
    v_and_b32_e64 v71, 1, v69
    v_lshl_add_u32 v70, v71, 9, v70
    v_lshl_add_u32 v66, v68, 4, v70
    s_lshr_b32 s90, s2, 2
    s_lshl_b32 s90, s90, 15
    s_and_b32 s71, s2, 3
    s_lshl_b32 s71, s71, 7
    s_add_u32 s90, s90, s71
    s_add_u32 s90, s90, 1048576
    s_add_u32 s91, s90, 16384
    s_nop 0
    v_bfe_u32 v68, v1, 2, 2
    v_mul_u32_u24 v68, 1088, v68
    v_lshrrev_b32_e64 v69, 4, v1
    v_lshl_add_u32 v68, v69, 5, v68
    v_and_b32_e64 v69, 3, v1
    v_lshl_add_u32 v68, v69, 3, v68
    s_lshl_b32 s72, s60, 8
    s_add_u32 s72, s72, 143936
    v_add_u32 v67, s72, v68
    s_lshl_b32 s92, s2, 13
    s_lshl_b32 s73, s60, 11
    s_add_u32 s92, s92, s73
    s_add_u32 s92, s92, 3145728
    s_lshr_b32 s93, s2, 4
    s_lshl_b32 s93, s93, 8
    s_and_b32 s72, s2, 15
    s_lshl_b32 s72, s72, 2
    s_add_u32 s93, s93, s72
    s_add_u32 s93, s93, 4096
    s_waitcnt vmcnt(10)
    s_add_u32 s72, s101, 1
    s_and_b32 s72, s72, 7
    s_mul_i32 s72, s72, 229376
    s_add_u32 s5, s72, s80
    s_add_u32 m0, s79, 16384
    s_add_u32 s34, s5, 0
    buffer_load_dwordx4 v22, s[44:47], s34 offen lds
    s_add_u32 m0, s79, 17408
    s_add_u32 s34, s5, 28672
    buffer_load_dwordx4 v22, s[44:47], s34 offen lds
    s_add_u32 m0, s79, 18432
    s_add_u32 s34, s5, 57344
    buffer_load_dwordx4 v22, s[44:47], s34 offen lds
    s_add_u32 m0, s79, 19456
    s_add_u32 s34, s5, 86016
    buffer_load_dwordx4 v22, s[44:47], s34 offen lds
    v_readfirstlane_b32 s68, v4
    v_lshlrev_b32 v32, 16, v8
    v_and_b32 v33, s78, v8
    v_lshlrev_b32 v34, 16, v9
    v_and_b32 v35, s78, v9
    v_lshlrev_b32 v36, 16, v10
    v_and_b32 v37, s78, v10
    v_lshlrev_b32 v38, 16, v11
    v_and_b32 v39, s78, v11
    v_lshlrev_b32 v40, 16, v12
    v_and_b32 v41, s78, v12
    v_lshlrev_b32 v42, 16, v13
    v_and_b32 v43, s78, v13
    v_lshlrev_b32 v44, 16, v14
    v_and_b32 v45, s78, v14
    v_lshlrev_b32 v46, 16, v15
    v_and_b32 v47, s78, v15
    s_mul_i32 s68, s68, 1664525
    s_add_u32 s68, s68, 1013904223
    v_pk_add_f32 v[72:73], v[32:33], v[34:35]
    v_pk_mul_f32 v[76:77], v[32:33], v[32:33]
    v_pk_add_f32 v[74:75], v[36:37], v[38:39]
    v_pk_mul_f32 v[78:79], v[34:35], v[34:35]
    v_pk_fma_f32 v[76:77], v[36:37], v[36:37], v[76:77]
    v_pk_fma_f32 v[78:79], v[38:39], v[38:39], v[78:79]
    v_pk_add_f32 v[72:73], v[72:73], v[40:41]
    v_pk_add_f32 v[74:75], v[74:75], v[42:43]
    v_pk_fma_f32 v[76:77], v[40:41], v[40:41], v[76:77]
    v_pk_fma_f32 v[78:79], v[42:43], v[42:43], v[78:79]
    v_pk_add_f32 v[72:73], v[72:73], v[44:45]
    v_pk_add_f32 v[74:75], v[74:75], v[46:47]
    v_pk_fma_f32 v[76:77], v[44:45], v[44:45], v[76:77]
    v_pk_fma_f32 v[78:79], v[46:47], v[46:47], v[78:79]
    v_pk_add_f32 v[72:73], v[72:73], v[74:75]
    v_pk_add_f32 v[76:77], v[76:77], v[78:79]
    v_add_f32 v70, v72, v73
    v_add_f32_e64 v69, v76, v77
    s_nop 0
    v_add_f32_dpp v70, v70, v70 quad_perm:[1,0,3,2] row_mask:0xf bank_mask:0xf
    v_add_f32_dpp v69, v69, v69 quad_perm:[1,0,3,2] row_mask:0xf bank_mask:0xf
    s_nop 0
    s_nop 0
    v_add_f32_dpp v70, v70, v70 quad_perm:[2,3,0,1] row_mask:0xf bank_mask:0xf
    v_add_f32_dpp v69, v69, v69 quad_perm:[2,3,0,1] row_mask:0xf bank_mask:0xf
    s_nop 0
    s_nop 0
    v_add_f32_dpp v70, v70, v70 row_half_mirror row_mask:0xf bank_mask:0xf
    v_add_f32_dpp v69, v69, v69 row_half_mirror row_mask:0xf bank_mask:0xf
    s_nop 0
    s_nop 0
    v_add_f32_dpp v70, v70, v70 row_mirror row_mask:0xf bank_mask:0xf
    v_add_f32_dpp v69, v69, v69 row_mirror row_mask:0xf bank_mask:0xf
    v_mov_b32 v72, v70
    v_mov_b32 v73, v69
    s_nop 1
    v_permlane16_swap_b32 v70, v72
    v_permlane16_swap_b32 v69, v73
    s_nop 1
    v_add_f32 v70, v70, v72
    v_add_f32 v69, v69, v73
    v_mul_f32 v70, 0x3b000000, v70
    v_mul_f32 v69, 0x3b000000, v69
    v_fma_f32 v69, -v70, v70, v69
    v_max_f32_e64 v69, 0, v69
    v_cvt_pk_bf16_f32 v72, v70, v69
    v_lshlrev_b32 v70, 16, v72
    v_and_b32 v69, s78, v72
    v_add_f32 v69, 0x3727c5ac, v69
    v_cvt_pk_bf16_f32 v69, v69, v69
    v_lshlrev_b32 v69, 16, v69
    v_sqrt_f32 v69, v69
    v_pk_add_f32 v[48:49], v[32:33], v[70:71] op_sel_hi:[1,0] neg_lo:[0,1] neg_hi:[0,1]
    v_cvt_pk_bf16_f32 v74, v69, v69
    v_pk_add_f32 v[50:51], v[34:35], v[70:71] op_sel_hi:[1,0] neg_lo:[0,1] neg_hi:[0,1]
    v_lshlrev_b32_e64 v74, 16, v74
    v_pk_add_f32 v[52:53], v[36:37], v[70:71] op_sel_hi:[1,0] neg_lo:[0,1] neg_hi:[0,1]
    v_rcp_f32_e64 v72, v74
    v_pk_add_f32 v[54:55], v[38:39], v[70:71] op_sel_hi:[1,0] neg_lo:[0,1] neg_hi:[0,1]
    v_pk_add_f32 v[56:57], v[40:41], v[70:71] op_sel_hi:[1,0] neg_lo:[0,1] neg_hi:[0,1]
    v_pk_add_f32 v[58:59], v[42:43], v[70:71] op_sel_hi:[1,0] neg_lo:[0,1] neg_hi:[0,1]
    v_pk_add_f32 v[60:61], v[44:45], v[70:71] op_sel_hi:[1,0] neg_lo:[0,1] neg_hi:[0,1]
    v_pk_add_f32 v[62:63], v[46:47], v[70:71] op_sel_hi:[1,0] neg_lo:[0,1] neg_hi:[0,1]
    v_cvt_pk_bf16_f32 v32, v48, v49
    v_cvt_pk_bf16_f32 v33, v50, v51
    v_cvt_pk_bf16_f32 v34, v52, v53
    v_cvt_pk_bf16_f32 v35, v54, v55
    v_cvt_pk_bf16_f32 v36, v56, v57
    v_cvt_pk_bf16_f32 v37, v58, v59
    v_cvt_pk_bf16_f32 v38, v60, v61
    v_cvt_pk_bf16_f32 v39, v62, v63
    v_lshlrev_b32 v48, 16, v32
    v_and_b32 v49, s78, v32
    v_lshlrev_b32 v50, 16, v33
    v_and_b32 v51, s78, v33
    v_lshlrev_b32 v52, 16, v34
    v_and_b32 v53, s78, v34
    v_lshlrev_b32 v54, 16, v35
    v_and_b32 v55, s78, v35
    v_lshlrev_b32 v56, 16, v36
    v_and_b32 v57, s78, v36
    v_lshlrev_b32 v58, 16, v37
    v_and_b32 v59, s78, v37
    v_lshlrev_b32 v60, 16, v38
    v_and_b32 v61, s78, v38
    v_lshlrev_b32 v62, 16, v39
    v_and_b32 v63, s78, v39
    v_pk_mul_f32 v[48:49], v[48:49], v[72:73] op_sel_hi:[1,0]
    v_pk_mul_f32 v[50:51], v[50:51], v[72:73] op_sel_hi:[1,0]
    v_pk_mul_f32 v[52:53], v[52:53], v[72:73] op_sel_hi:[1,0]
    v_pk_mul_f32 v[54:55], v[54:55], v[72:73] op_sel_hi:[1,0]
    v_pk_mul_f32 v[56:57], v[56:57], v[72:73] op_sel_hi:[1,0]
    v_pk_mul_f32 v[58:59], v[58:59], v[72:73] op_sel_hi:[1,0]
    v_pk_mul_f32 v[60:61], v[60:61], v[72:73] op_sel_hi:[1,0]
    v_pk_mul_f32 v[62:63], v[62:63], v[72:73] op_sel_hi:[1,0]
    v_cvt_pk_bf16_f32 v32, v48, v49
    v_cvt_pk_bf16_f32 v33, v50, v51
    v_cvt_pk_bf16_f32 v34, v52, v53
    v_cvt_pk_bf16_f32 v35, v54, v55
    v_cvt_pk_bf16_f32 v36, v56, v57
    v_cvt_pk_bf16_f32 v37, v58, v59
    v_cvt_pk_bf16_f32 v38, v60, v61
    v_cvt_pk_bf16_f32 v39, v62, v63
    ds_write_b128 v64, v[32:35]
    ds_write_b128 v64, v[36:39] offset:512
    s_waitcnt lgkmcnt(0)
    s_barrier
    ds_read_b128 v[32:35], v65
    ds_read_b128 v[36:39], v65 offset:512
    ds_read_b64_tr_b16 v[40:41], v67
    ds_read_b64_tr_b16 v[42:43], v67 offset:4352
    ds_read_b64_tr_b16 v[44:45], v67 offset:128
    ds_read_b64_tr_b16 v[46:47], v67 offset:4480
    s_waitcnt lgkmcnt(5)
    buffer_store_dwordx4 v[32:35], v66, s[40:43], s90 offen sc0 sc1
    s_waitcnt lgkmcnt(4)
    buffer_store_dwordx4 v[36:39], v66, s[40:43], s91 offen sc0 sc1
    s_waitcnt lgkmcnt(2)
    buffer_store_dwordx4 v[40:43], v2, s[40:43], s92 offen sc0 sc1
    s_waitcnt lgkmcnt(0)
    buffer_store_dwordx4 v[44:47], v2, s[40:43], s92 offen offset:1024 sc0 sc1
    s_add_u32 s72, s101, 1
    s_and_b32 s72, s72, 7
    s_mul_i32 s72, s72, 229376
    s_add_u32 s5, s72, s80
    s_add_u32 s72, s101, 2
    s_and_b32 s72, s72, 7
    s_mul_i32 s72, s72, 229376
    s_add_u32 s6, s72, s80
    s_add_u32 s72, s101, 3
    s_and_b32 s72, s72, 7
    s_mul_i32 s72, s72, 229376
    s_add_u32 s7, s72, s80
    s_add_u32 s72, s101, 4
    s_and_b32 s72, s72, 7
    s_mul_i32 s72, s72, 229376
    s_add_u32 s8, s72, s80
    s_add_u32 s72, s101, 5
    s_and_b32 s72, s72, 7
    s_mul_i32 s72, s72, 229376
    s_add_u32 s9, s72, s80
    s_add_u32 s72, s101, 6
    s_and_b32 s72, s72, 7
    s_mul_i32 s72, s72, 229376
    s_add_u32 s10, s72, s80
    s_add_u32 s72, s101, 7
    s_and_b32 s72, s72, 7
    s_mul_i32 s72, s72, 229376
    s_add_u32 s11, s72, s80
    s_add_u32 s72, s101, 0
    s_and_b32 s72, s72, 7
    s_lshl_b32 s72, s72, 12
    s_add_u32 s12, s72, s51
    s_add_u32 s72, s101, 1
    s_and_b32 s72, s72, 7
    s_lshl_b32 s72, s72, 12
    s_add_u32 s13, s72, s51
    s_add_u32 s72, s101, 2
    s_and_b32 s72, s72, 7
    s_lshl_b32 s72, s72, 12
    s_add_u32 s14, s72, s51
    s_add_u32 s72, s101, 3
    s_and_b32 s72, s72, 7
    s_lshl_b32 s72, s72, 12
    s_add_u32 s15, s72, s51
    s_add_u32 s72, s101, 4
    s_and_b32 s72, s72, 7
    s_lshl_b32 s72, s72, 12
    s_add_u32 s16, s72, s51
    s_add_u32 s72, s101, 5
    s_and_b32 s72, s72, 7
    s_lshl_b32 s72, s72, 12
    s_add_u32 s17, s72, s51
    s_add_u32 s72, s101, 6
    s_and_b32 s72, s72, 7
    s_lshl_b32 s72, s72, 12
    s_add_u32 s18, s72, s51
    s_add_u32 s72, s101, 7
    s_and_b32 s72, s72, 7
    s_lshl_b32 s72, s72, 12
    s_add_u32 s19, s72, s51
    s_mul_i32 s73, s66, 229376
    s_add_u32 s73, s73, 5242880
    s_mul_i32 s100, s67, 229376
    s_add_u32 s100, s100, 15728640
    s_lshr_b32 s71, s62, 3
    s_add_u32 s71, s71, s67
    s_add_u32 s72, s71, 0
    s_and_b32 s72, s72, 3
    s_lshl_b32 s72, s72, 2
    s_lshl_b32 s70, s60, 4
    s_add_u32 s72, s72, s70
    s_lshl_b32 s70, s72, 10
    s_add_u32 s20, s70, s73
    s_lshl_b32 s70, s72, 11
    s_add_u32 s27, s70, s100
    s_add_u32 s72, s71, 1
    s_and_b32 s72, s72, 3
    s_lshl_b32 s72, s72, 2
    s_lshl_b32 s70, s60, 4
    s_add_u32 s72, s72, s70
    s_lshl_b32 s70, s72, 10
    s_add_u32 s21, s70, s73
    s_lshl_b32 s70, s72, 11
    s_add_u32 s28, s70, s100
    s_add_u32 s72, s71, 2
    s_and_b32 s72, s72, 3
    s_lshl_b32 s72, s72, 2
    s_lshl_b32 s70, s60, 4
    s_add_u32 s72, s72, s70
    s_lshl_b32 s70, s72, 10
    s_add_u32 s22, s70, s73
    s_lshl_b32 s70, s72, 11
    s_add_u32 s29, s70, s100
    s_add_u32 s72, s71, 3
    s_and_b32 s72, s72, 3
    s_lshl_b32 s72, s72, 2
    s_lshl_b32 s70, s60, 4
    s_add_u32 s72, s72, s70
    s_lshl_b32 s70, s72, 10
    s_add_u32 s23, s70, s73
    s_lshl_b32 s70, s72, 11
    s_add_u32 s30, s70, s100
    s_add_u32 s72, s71, 0
    s_mul_i32 s70, s72, 43
    s_lshr_b32 s70, s70, 7
    s_mul_i32 s70, s70, 3
    s_sub_u32 s72, s72, s70
    s_lshl_b32 s72, s72, 2
    s_mul_i32 s70, s60, 12
    s_add_u32 s72, s72, s70
    s_add_u32 s72, s72, 64
    s_lshl_b32 s70, s72, 10
    s_add_u32 s24, s70, s73
    s_lshl_b32 s70, s72, 11
    s_add_u32 s31, s70, s100
    s_add_u32 s72, s71, 1
    s_mul_i32 s70, s72, 43
    s_lshr_b32 s70, s70, 7
    s_mul_i32 s70, s70, 3
    s_sub_u32 s72, s72, s70
    s_lshl_b32 s72, s72, 2
    s_mul_i32 s70, s60, 12
    s_add_u32 s72, s72, s70
    s_add_u32 s72, s72, 64
    s_lshl_b32 s70, s72, 10
    s_add_u32 s25, s70, s73
    s_lshl_b32 s70, s72, 11
    s_add_u32 s32, s70, s100
    s_add_u32 s72, s71, 2
    s_mul_i32 s70, s72, 43
    s_lshr_b32 s70, s70, 7
    s_mul_i32 s70, s70, 3
    s_sub_u32 s72, s72, s70
    s_lshl_b32 s72, s72, 2
    s_mul_i32 s70, s60, 12
    s_add_u32 s72, s72, s70
    s_add_u32 s72, s72, 64
    s_lshl_b32 s70, s72, 10
    s_add_u32 s26, s70, s73
    s_lshl_b32 s70, s72, 11
    s_add_u32 s33, s70, s100
    v_and_b32 v112, 15, v1
    v_lshrrev_b32 v113, 4, v1
    s_mul_i32 s72, s82, 1392
    s_add_u32 s72, s72, 161040
    s_cmp_eq_u32 s81, 0
    s_cbranch_scc0 L_kt_hv1
    v_and_b32 v120, 1, v113
    v_lshlrev_b32 v120, 2, v120
    v_lshrrev_b32_e64 v121, 1, v113
    v_lshl_add_u32 v120, v121, 7, v120
    v_lshl_add_u32 v114, v112, 3, v120
    v_mov_b32 v115, 1
    v_mov_b32 v116, 2
    v_mov_b32 v117, v114
    v_mov_b32 v118, 1
    v_mov_b32 v119, 2
    s_branch L_kt_done
L_kt_hv1:
    v_cmp_gt_u32 vcc, 2, v113
    v_lshlrev_b32 v120, 6, v113
    v_lshlrev_b32 v121, 1, v112
    v_lshlrev_b32 v122, 2, v112
    v_cndmask_b32 v121, v121, v122, vcc
    v_add_u32 v114, v120, v121
    v_add_u32 v114, 0x100, v114
    v_mov_b32 v115, 1
    v_mov_b32 v116, 32
    v_mov_b32 v122, 2
    v_cndmask_b32 v116, v116, v122, vcc
    v_add_u32_e64 v117, v120, v112
    v_add_u32 v117, 0x200, v117
    v_mov_b32 v118, 16
    v_mov_b32 v119, 16
    v_mov_b32_e64 v122, 32
    v_cndmask_b32 v119, v119, v122, vcc
    v_cmp_eq_u32 vcc, 3, v113
    v_add_u32 v122, 0x290, v112
    v_mov_b32 v123, 0
    v_cndmask_b32 v117, v117, v122, vcc
    v_cndmask_b32 v118, v118, v123, vcc
    v_cndmask_b32 v119, v119, v123, vcc
L_kt_done:
    v_lshl_add_u32 v245, v114, 1, s72
    v_lshl_add_u32 v246, v115, 1, v245
    v_lshl_add_u32 v247, v116, 1, v245
    v_lshl_add_u32 v248, v116, 1, v246
    v_lshl_add_u32 v249, v117, 1, s72
    v_lshl_add_u32 v250, v118, 1, v249
    v_lshl_add_u32 v251, v119, 1, v249
    v_lshl_add_u32 v252, v119, 1, v250
    v_lshrrev_b32 v124, 4, v1
    v_lshrrev_b32 v125, 1, v124
    v_bfe_u32 v126, v1, 2, 2
    v_lshl_add_u32 v125, v125, 2, v126
    v_lshlrev_b32 v125, 7, v125
    v_and_b32 v124, 1, v124
    v_lshlrev_b32_e64 v124, 1, v124
    v_bfe_u32 v127, v1, 1, 1
    v_add_u32 v124, v124, v127
    v_lshrrev_b32 v126, 1, v126
    v_lshlrev_b32 v126, 2, v126
    v_xor_b32 v127, v124, v126
    v_xor_b32 v126, 4, v127
    v_and_b32 v124, 1, v1
    v_lshl_add_u32 v125, v124, 3, v125
    v_lshl_add_u32 v127, v127, 4, v125
    v_lshl_add_u32 v126, v126, 4, v125
    s_lshl_b32 s70, s60, 11
    s_add_u32 s70, s70, 143936
    v_add_u32 v200, s70, v127
    v_add_u32_e64 v201, s70, v126
    v_add_u32 v253, 4096, v2
    s_lshl_b32 s70, s2, 2
    s_add_u32 s70, s70, s60
    s_and_b32 s71, s70, 7
    s_lshr_b32 s72, s70, 3
    s_lshl_b32 s49, s72, 14
    s_lshl_b32 s73, s71, 7
    s_add_u32 s49, s49, s73
    s_mul_i32 s71, s71, 112
    s_add_u32 s71, s71, s72
    s_lshl_b32 s50, s71, 11
    s_add_u32 s50, s50, 15728640
    s_cmp_lt_u32 s70, 896
    s_cselect_b32 s49, s49, 0x7ff00000
    s_cselect_b32 s50, s50, 0x7ff00000
    s_add_u32 m0, s79, 32768
    s_add_u32 s34, s6, 0
    buffer_load_dwordx4 v22, s[44:47], s34 offen lds
    s_add_u32 m0, s79, 33792
    s_add_u32 s34, s6, 28672
    buffer_load_dwordx4 v22, s[44:47], s34 offen lds
    s_add_u32 m0, s79, 34816
    s_add_u32 s34, s6, 57344
    buffer_load_dwordx4 v22, s[44:47], s34 offen lds
    s_add_u32 m0, s79, 35840
    s_add_u32 s34, s6, 86016
    buffer_load_dwordx4 v22, s[44:47], s34 offen lds
    s_waitcnt vmcnt(16)
    v_lshlrev_b32 v16, 16, v16
    v_lshlrev_b32 v17, 16, v17
    v_lshlrev_b32 v18, 16, v18
    v_lshlrev_b32 v19, 16, v19
    v_lshlrev_b32 v20, 16, v20
    v_lshlrev_b32 v21, 16, v21
    s_lshl_b32 s3, s76, 16
    s_and_b32 s48, s76, s78
    s_cmp_eq_u32 s82, 0
    s_cselect_b32 s3, s3, s48
    v_mov_b32 v48, s3
    v_mul_f32 v48, 0x3fb8aa3b, v48
    v_exp_f32 v48, v48
    s_nop 0
    v_cvt_pk_bf16_f32 v48, v48, v48
    v_lshlrev_b32 v48, 16, v48
    v_mul_f32 v50, v48, v16
    v_mul_f32_e64 v51, v48, v17
    v_mul_f32 v50, 0x3fb8aa3b, v50
    v_mul_f32 v51, 0x3e22f983, v51
    v_mul_f32 v52, v48, v18
    v_mul_f32_e64 v53, v48, v19
    v_pk_mul_f32 v[62:63], v[20:21], v[52:53] op_sel:[0,0] op_sel_hi:[1,0]
    v_pk_fma_f32 v[60:61], v[20:21], v[52:53], v[62:63] op_sel:[1,1,0] op_sel_hi:[0,1,1] neg_lo:[1,0,0]
    v_mul_f32 v62, 0x3f800000, v50
    v_mul_f32 v63, 0x3f800000, v51
    v_exp_f32 v62, v62
    v_fract_f32 v63, v63
    v_cos_f32 v64, v63
    v_sin_f32 v65, v63
    s_waitcnt vmcnt(4)
    s_barrier
    s_add_u32 s99, s93, s69
    v_mov_b32 v254, s99
    v_mov_b32 v255, s68
    s_mov_b64 exec, 1
    buffer_store_dword v255, v254, s[40:43], 0 offen sc0 sc1
    s_mov_b64 exec, -1
    s_nop 0
    v_mul_f32 v54, v62, v64
    v_mul_f32 v55, v62, v65
    v_mul_f32 v66, 0x41000000, v50
    s_lshl_b32 s99, s60, 11
    s_nop 0
    v_mul_f32 v67, 0x41000000, v51
    v_exp_f32 v66, v66
    v_fract_f32 v67, v67
    s_add_u32 m0, s99, 143936
    v_cos_f32 v68, v67
    v_sin_f32 v69, v67
    s_nop 0
    v_mul_f32 v56, v66, v68
    s_add_u32 s34, s49, 0
    v_mul_f32 v57, v66, v69
    v_mul_f32 v62, 0x43000000, v50
    v_mul_f32 v63, 0x43000000, v51
    buffer_load_dwordx4 v26, s[52:55], s34 offen lds
    v_exp_f32 v62, v62
    v_fract_f32 v63, v63
    v_cos_f32 v64, v63
    v_sin_f32 v65, v63
    s_lshl_b32 s99, s60, 11
    s_nop 0
    v_mul_f32 v58, v62, v64
    v_mul_f32 v59, v62, v65
    v_pk_mul_f32 v[62:63], v[54:55], v[54:55] op_sel:[0,0] op_sel_hi:[1,0]
    s_add_u32 m0, s99, 144960
    v_pk_fma_f32 v[70:71], v[54:55], v[54:55], v[62:63] op_sel:[1,1,0] op_sel_hi:[0,1,1] neg_lo:[1,0,0]
    v_pk_mul_f32 v[64:65], v[58:59], v[58:59] op_sel:[0,0] op_sel_hi:[1,0]
    v_pk_fma_f32 v[74:75], v[58:59], v[58:59], v[64:65] op_sel:[1,1,0] op_sel_hi:[0,1,1] neg_lo:[1,0,0]
    s_add_u32 s34, s49, 8192
    v_mov_b32_e64 v80, v56
    v_xor_b32 v81, 0x80000000, v57
    v_pk_mul_f32 v[62:63], v[70:71], v[70:71] op_sel:[0,0] op_sel_hi:[1,0]
    v_pk_fma_f32 v[72:73], v[70:71], v[70:71], v[62:63] op_sel:[1,1,0] op_sel_hi:[0,1,1] neg_lo:[1,0,0]
    buffer_load_dwordx4 v26, s[52:55], s34 offen lds
    v_pk_mul_f32 v[64:65], v[74:75], v[74:75] op_sel:[0,0] op_sel_hi:[1,0]
    v_pk_fma_f32 v[76:77], v[74:75], v[74:75], v[64:65] op_sel:[1,1,0] op_sel_hi:[0,1,1] neg_lo:[1,0,0]
    v_pk_mul_f32 v[62:63], v[76:77], v[76:77] op_sel:[0,0] op_sel_hi:[1,0]
    v_pk_fma_f32 v[78:79], v[76:77], v[76:77], v[62:63] op_sel:[1,1,0] op_sel_hi:[0,1,1] neg_lo:[1,0,0]
    s_add_u32 m0, s79, 49152
    s_mul_i32 s3, s82, 31008
    s_lshl_b32 s48, s81, 8
    s_add_u32 s3, s3, s48
    s_add_u32 s34, s7, 0
    s_add_u32 s3, s3, 81920
    s_nop 0
    v_lshl_add_u32 v82, v1, 2, s3
    v_mov_b32 v83, 0x3f80
    ds_write_b32 v82, v83 offset:22304
    buffer_load_dwordx4 v22, s[44:47], s34 offen lds
    v_cvt_pk_bf16_f32 v84, v80, v81
    ds_write_b32 v82, v84 offset:22848
    v_cvt_pk_bf16_f32 v85, v60, v61
    s_add_u32 m0, s79, 50176
    ds_write_b32 v82, v85 offset:0
    v_pk_mul_f32 v[100:101], v[60:61], v[58:59] op_sel:[0,0] op_sel_hi:[1,0]
    v_pk_fma_f32 v[92:93], v[60:61], v[58:59], v[100:101] op_sel:[1,1,0] op_sel_hi:[0,1,1] neg_lo:[1,0,0]
    v_cvt_pk_bf16_f32 v86, v92, v93
    s_add_u32 s34, s7, 28672
    ds_write_b32 v82, v86 offset:4352
    v_pk_mul_f32 v[100:101], v[60:61], v[54:55] op_sel:[0,0] op_sel_hi:[1,0]
    v_pk_fma_f32 v[88:89], v[60:61], v[54:55], v[100:101] op_sel:[1,1,0] op_sel_hi:[0,1,1] neg_lo:[1,0,0]
    v_pk_mul_f32 v[98:99], v[80:81], v[80:81] op_sel:[0,0] op_sel_hi:[1,0]
    buffer_load_dwordx4 v22, s[44:47], s34 offen lds
    v_pk_fma_f32 v[94:95], v[80:81], v[80:81], v[98:99] op_sel:[1,1,0] op_sel_hi:[0,1,1] neg_lo:[1,0,0]
    v_cvt_pk_bf16_f32 v87, v88, v89
    ds_write_b32 v82, v87 offset:544
    s_add_u32 m0, s79, 51200
    v_cvt_pk_bf16_f32 v84, v94, v95
    ds_write_b32 v82, v84 offset:23392
    v_pk_mul_f32 v[100:101], v[88:89], v[58:59] op_sel:[0,0] op_sel_hi:[1,0]
    v_pk_fma_f32 v[92:93], v[88:89], v[58:59], v[100:101] op_sel:[1,1,0] op_sel_hi:[0,1,1] neg_lo:[1,0,0]
    s_add_u32 s34, s7, 57344
    v_cvt_pk_bf16_f32 v85, v92, v93
    ds_write_b32 v82, v85 offset:4896
    v_pk_mul_f32 v[100:101], v[88:89], v[54:55] op_sel:[0,0] op_sel_hi:[1,0]
    v_pk_fma_f32 v[90:91], v[88:89], v[54:55], v[100:101] op_sel:[1,1,0] op_sel_hi:[0,1,1] neg_lo:[1,0,0]
    buffer_load_dwordx4 v22, s[44:47], s34 offen lds
    v_pk_mul_f32 v[98:99], v[94:95], v[80:81] op_sel:[0,0] op_sel_hi:[1,0]
    v_pk_fma_f32 v[96:97], v[94:95], v[80:81], v[98:99] op_sel:[1,1,0] op_sel_hi:[0,1,1] neg_lo:[1,0,0]
    v_cvt_pk_bf16_f32 v86, v90, v91
    s_add_u32 m0, s79, 52224
    ds_write_b32 v82, v86 offset:1088
    v_cvt_pk_bf16_f32 v87, v96, v97
    ds_write_b32 v82, v87 offset:23936
    v_pk_mul_f32 v[100:101], v[90:91], v[58:59] op_sel:[0,0] op_sel_hi:[1,0]
    s_add_u32 s34, s7, 86016
    v_pk_fma_f32 v[92:93], v[90:91], v[58:59], v[100:101] op_sel:[1,1,0] op_sel_hi:[0,1,1] neg_lo:[1,0,0]
    v_cvt_pk_bf16_f32 v84, v92, v93
    ds_write_b32 v82, v84 offset:5440
    buffer_load_dwordx4 v22, s[44:47], s34 offen lds
    v_pk_mul_f32 v[100:101], v[90:91], v[54:55] op_sel:[0,0] op_sel_hi:[1,0]
    v_pk_fma_f32 v[88:89], v[90:91], v[54:55], v[100:101] op_sel:[1,1,0] op_sel_hi:[0,1,1] neg_lo:[1,0,0]
    v_pk_mul_f32 v[98:99], v[96:97], v[80:81] op_sel:[0,0] op_sel_hi:[1,0]
    v_pk_fma_f32 v[94:95], v[96:97], v[80:81], v[98:99] op_sel:[1,1,0] op_sel_hi:[0,1,1] neg_lo:[1,0,0]
    s_add_u32 m0, s79, 65536
    v_cvt_pk_bf16_f32 v85, v88, v89
    ds_write_b32 v82, v85 offset:1632
    v_cvt_pk_bf16_f32 v86, v94, v95
    ds_write_b32 v82, v86 offset:24480
    s_add_u32 s34, s8, 0
    s_nop 0
    v_pk_mul_f32 v[100:101], v[88:89], v[58:59] op_sel:[0,0] op_sel_hi:[1,0]
    v_pk_fma_f32 v[92:93], v[88:89], v[58:59], v[100:101] op_sel:[1,1,0] op_sel_hi:[0,1,1] neg_lo:[1,0,0]
    v_cvt_pk_bf16_f32 v87, v92, v93
    buffer_load_dwordx4 v22, s[44:47], s34 offen lds
    ds_write_b32 v82, v87 offset:5984
    v_pk_mul_f32 v[100:101], v[88:89], v[54:55] op_sel:[0,0] op_sel_hi:[1,0]
    v_pk_fma_f32 v[90:91], v[88:89], v[54:55], v[100:101] op_sel:[1,1,0] op_sel_hi:[0,1,1] neg_lo:[1,0,0]
    v_pk_mul_f32 v[98:99], v[94:95], v[80:81] op_sel:[0,0] op_sel_hi:[1,0]
    s_add_u32 m0, s79, 66560
    v_pk_fma_f32 v[96:97], v[94:95], v[80:81], v[98:99] op_sel:[1,1,0] op_sel_hi:[0,1,1] neg_lo:[1,0,0]
    v_cvt_pk_bf16_f32 v84, v90, v91
    ds_write_b32 v82, v84 offset:2176
    v_cvt_pk_bf16_f32 v85, v96, v97
    s_add_u32 s34, s8, 28672
    ds_write_b32 v82, v85 offset:25024
    v_pk_mul_f32 v[100:101], v[90:91], v[58:59] op_sel:[0,0] op_sel_hi:[1,0]
    v_pk_fma_f32 v[92:93], v[90:91], v[58:59], v[100:101] op_sel:[1,1,0] op_sel_hi:[0,1,1] neg_lo:[1,0,0]
    buffer_load_dwordx4 v22, s[44:47], s34 offen lds
    v_cvt_pk_bf16_f32 v86, v92, v93
    ds_write_b32 v82, v86 offset:6528
    v_pk_mul_f32 v[100:101], v[90:91], v[54:55] op_sel:[0,0] op_sel_hi:[1,0]
    v_pk_fma_f32 v[88:89], v[90:91], v[54:55], v[100:101] op_sel:[1,1,0] op_sel_hi:[0,1,1] neg_lo:[1,0,0]
    s_add_u32 m0, s79, 67584
    v_pk_mul_f32 v[98:99], v[96:97], v[80:81] op_sel:[0,0] op_sel_hi:[1,0]
    v_pk_fma_f32 v[94:95], v[96:97], v[80:81], v[98:99] op_sel:[1,1,0] op_sel_hi:[0,1,1] neg_lo:[1,0,0]
    v_cvt_pk_bf16_f32 v87, v88, v89
    s_add_u32 s34, s8, 57344
    ds_write_b32 v82, v87 offset:2720
    v_cvt_pk_bf16_f32 v84, v94, v95
    ds_write_b32 v82, v84 offset:25568
    v_pk_mul_f32 v[100:101], v[88:89], v[58:59] op_sel:[0,0] op_sel_hi:[1,0]
    buffer_load_dwordx4 v22, s[44:47], s34 offen lds
    v_pk_fma_f32 v[92:93], v[88:89], v[58:59], v[100:101] op_sel:[1,1,0] op_sel_hi:[0,1,1] neg_lo:[1,0,0]
    v_cvt_pk_bf16_f32 v85, v92, v93
    ds_write_b32 v82, v85 offset:7072
    v_pk_mul_f32 v[100:101], v[88:89], v[54:55] op_sel:[0,0] op_sel_hi:[1,0]
    s_add_u32 m0, s79, 68608
    v_pk_fma_f32 v[90:91], v[88:89], v[54:55], v[100:101] op_sel:[1,1,0] op_sel_hi:[0,1,1] neg_lo:[1,0,0]
    v_pk_mul_f32 v[98:99], v[94:95], v[80:81] op_sel:[0,0] op_sel_hi:[1,0]
    v_pk_fma_f32 v[96:97], v[94:95], v[80:81], v[98:99] op_sel:[1,1,0] op_sel_hi:[0,1,1] neg_lo:[1,0,0]
    s_add_u32 s34, s8, 86016
    v_cvt_pk_bf16_f32 v86, v90, v91
    ds_write_b32 v82, v86 offset:3264
    v_cvt_pk_bf16_f32 v87, v96, v97
    ds_write_b32 v82, v87 offset:26112
    buffer_load_dwordx4 v22, s[44:47], s34 offen lds
    v_pk_mul_f32 v[100:101], v[90:91], v[58:59] op_sel:[0,0] op_sel_hi:[1,0]
    v_pk_fma_f32 v[92:93], v[90:91], v[58:59], v[100:101] op_sel:[1,1,0] op_sel_hi:[0,1,1] neg_lo:[1,0,0]
    v_cvt_pk_bf16_f32 v84, v92, v93
    ds_write_b32 v82, v84 offset:7616
    v_pk_mul_f32 v[100:101], v[90:91], v[54:55] op_sel:[0,0] op_sel_hi:[1,0]
    v_pk_fma_f32 v[88:89], v[90:91], v[54:55], v[100:101] op_sel:[1,1,0] op_sel_hi:[0,1,1] neg_lo:[1,0,0]
    v_pk_mul_f32 v[98:99], v[96:97], v[80:81] op_sel:[0,0] op_sel_hi:[1,0]
    v_pk_fma_f32 v[94:95], v[96:97], v[80:81], v[98:99] op_sel:[1,1,0] op_sel_hi:[0,1,1] neg_lo:[1,0,0]
    v_cvt_pk_bf16_f32 v85, v88, v89
    ds_write_b32 v82, v85 offset:3808
    v_cvt_pk_bf16_f32 v86, v94, v95
    ds_write_b32 v82, v86 offset:26656
    v_pk_mul_f32 v[100:101], v[88:89], v[58:59] op_sel:[0,0] op_sel_hi:[1,0]
    v_pk_fma_f32 v[92:93], v[88:89], v[58:59], v[100:101] op_sel:[1,1,0] op_sel_hi:[0,1,1] neg_lo:[1,0,0]
    v_cvt_pk_bf16_f32 v87, v92, v93
    ds_write_b32 v82, v87 offset:8160
    v_pk_mul_f32 v[100:101], v[60:61], v[74:75] op_sel:[0,0] op_sel_hi:[1,0]
    v_pk_fma_f32 v[88:89], v[60:61], v[74:75], v[100:101] op_sel:[1,1,0] op_sel_hi:[0,1,1] neg_lo:[1,0,0]
    v_pk_mul_f32 v[98:99], v[94:95], v[80:81] op_sel:[0,0] op_sel_hi:[1,0]
    v_pk_fma_f32 v[96:97], v[94:95], v[80:81], v[98:99] op_sel:[1,1,0] op_sel_hi:[0,1,1] neg_lo:[1,0,0]
    v_cvt_pk_bf16_f32 v84, v96, v97
    ds_write_b32 v82, v84 offset:27200
    v_cvt_pk_bf16_f32 v85, v88, v89
    ds_write_b32 v82, v85 offset:8704
    v_pk_mul_f32 v[100:101], v[88:89], v[58:59] op_sel:[0,0] op_sel_hi:[1,0]
    v_pk_fma_f32 v[92:93], v[88:89], v[58:59], v[100:101] op_sel:[1,1,0] op_sel_hi:[0,1,1] neg_lo:[1,0,0]
    v_cvt_pk_bf16_f32 v86, v92, v93
    ds_write_b32 v82, v86 offset:10880
    v_and_b32 v244, 3, v1
    v_lshlrev_b32 v244, 2, v244
    v_pk_mul_f32 v[100:101], v[88:89], v[70:71] op_sel:[0,0] op_sel_hi:[1,0]
    s_lshl_b32 s100, s64, 8
    s_add_u32 s100, s100, 4096
    s_nop 0
    v_pk_fma_f32 v[90:91], v[88:89], v[70:71], v[100:101] op_sel:[1,1,0] op_sel_hi:[0,1,1] neg_lo:[1,0,0]
    s_lshl_b32 s94, s60, 4
    s_nop 0
    v_pk_mul_f32 v[98:99], v[96:97], v[80:81] op_sel:[0,0] op_sel_hi:[1,0]
    s_add_u32 s100, s100, s94
    v_add_u32 v244, s100, v244
    v_pk_fma_f32 v[94:95], v[96:97], v[80:81], v[98:99] op_sel:[1,1,0] op_sel_hi:[0,1,1] neg_lo:[1,0,0]
    buffer_load_dword v240, v244, s[40:43], 0 offen sc0 sc1
    v_cvt_pk_bf16_f32 v87, v94, v95
    ds_write_b32 v82, v87 offset:27744
    v_cvt_pk_bf16_f32 v84, v90, v91
    ds_write_b32 v82, v84 offset:9248
    v_pk_mul_f32 v[100:101], v[90:91], v[58:59] op_sel:[0,0] op_sel_hi:[1,0]
    v_pk_fma_f32 v[92:93], v[90:91], v[58:59], v[100:101] op_sel:[1,1,0] op_sel_hi:[0,1,1] neg_lo:[1,0,0]
    v_cvt_pk_bf16_f32 v85, v92, v93
    ds_write_b32 v82, v85 offset:11424
    v_pk_mul_f32 v[100:101], v[90:91], v[70:71] op_sel:[0,0] op_sel_hi:[1,0]
    v_pk_fma_f32 v[88:89], v[90:91], v[70:71], v[100:101] op_sel:[1,1,0] op_sel_hi:[0,1,1] neg_lo:[1,0,0]
    v_pk_mul_f32 v[98:99], v[94:95], v[80:81] op_sel:[0,0] op_sel_hi:[1,0]
    v_pk_fma_f32 v[96:97], v[94:95], v[80:81], v[98:99] op_sel:[1,1,0] op_sel_hi:[0,1,1] neg_lo:[1,0,0]
    v_cvt_pk_bf16_f32 v86, v96, v97
    ds_write_b32 v82, v86 offset:28288
    v_cvt_pk_bf16_f32 v87, v88, v89
    ds_write_b32 v82, v87 offset:9792
    v_pk_mul_f32 v[100:101], v[88:89], v[58:59] op_sel:[0,0] op_sel_hi:[1,0]
    v_pk_fma_f32 v[92:93], v[88:89], v[58:59], v[100:101] op_sel:[1,1,0] op_sel_hi:[0,1,1] neg_lo:[1,0,0]
    v_cvt_pk_bf16_f32 v84, v92, v93
    ds_write_b32 v82, v84 offset:11968
    v_pk_mul_f32 v[100:101], v[88:89], v[70:71] op_sel:[0,0] op_sel_hi:[1,0]
    v_pk_fma_f32 v[90:91], v[88:89], v[70:71], v[100:101] op_sel:[1,1,0] op_sel_hi:[0,1,1] neg_lo:[1,0,0]
    v_pk_mul_f32 v[98:99], v[96:97], v[80:81] op_sel:[0,0] op_sel_hi:[1,0]
    v_pk_fma_f32 v[94:95], v[96:97], v[80:81], v[98:99] op_sel:[1,1,0] op_sel_hi:[0,1,1] neg_lo:[1,0,0]
    v_cvt_pk_bf16_f32 v85, v94, v95
    ds_write_b32 v82, v85 offset:28832
    v_cvt_pk_bf16_f32 v86, v90, v91
    ds_write_b32 v82, v86 offset:10336
    v_pk_mul_f32 v[100:101], v[90:91], v[58:59] op_sel:[0,0] op_sel_hi:[1,0]
    v_pk_fma_f32 v[92:93], v[90:91], v[58:59], v[100:101] op_sel:[1,1,0] op_sel_hi:[0,1,1] neg_lo:[1,0,0]
    v_cvt_pk_bf16_f32 v87, v92, v93
    ds_write_b32 v82, v87 offset:12512
    v_pk_mul_f32 v[100:101], v[60:61], v[76:77] op_sel:[0,0] op_sel_hi:[1,0]
    v_pk_fma_f32 v[102:103], v[60:61], v[76:77], v[100:101] op_sel:[1,1,0] op_sel_hi:[0,1,1] neg_lo:[1,0,0]
    v_pk_mul_f32 v[98:99], v[94:95], v[80:81] op_sel:[0,0] op_sel_hi:[1,0]
    v_pk_fma_f32 v[96:97], v[94:95], v[80:81], v[98:99] op_sel:[1,1,0] op_sel_hi:[0,1,1] neg_lo:[1,0,0]
    v_cvt_pk_bf16_f32 v84, v96, v97
    ds_write_b32 v82, v84 offset:29376
    v_pk_mul_f32 v[100:101], v[102:103], v[72:73] op_sel:[0,0] op_sel_hi:[1,0]
    v_pk_fma_f32 v[104:105], v[102:103], v[72:73], v[100:101] op_sel:[1,1,0] op_sel_hi:[0,1,1] neg_lo:[1,0,0]
    v_cvt_pk_bf16_f32 v85, v102, v103
    ds_write_b32 v82, v85 offset:13056
    v_cvt_pk_bf16_f32 v86, v104, v105
    ds_write_b32 v82, v86 offset:13600
    v_pk_mul_f32 v[100:101], v[102:103], v[58:59] op_sel:[0,0] op_sel_hi:[1,0]
    v_pk_fma_f32 v[102:103], v[102:103], v[58:59], v[100:101] op_sel:[1,1,0] op_sel_hi:[0,1,1] neg_lo:[1,0,0]
    s_waitcnt vmcnt(0)
    v_cmp_ne_u32 vcc, s68, v240
    s_nop 4
    s_cmp_eq_u64 vcc, 0
    s_cbranch_scc0 L_slow_g1
L_ok_g1:
    s_nop 0
    v_pk_mul_f32 v[98:99], v[104:105], v[58:59] op_sel:[0,0] op_sel_hi:[1,0]
    v_pk_fma_f32 v[104:105], v[104:105], v[58:59], v[98:99] op_sel:[1,1,0] op_sel_hi:[0,1,1] neg_lo:[1,0,0]
    buffer_load_dwordx4 a[0:3], v2, s[40:43], s12 offen offset:0 sc0 sc1
    v_cvt_pk_bf16_f32 v87, v102, v103
    ds_write_b32 v82, v87 offset:14144
    v_cvt_pk_bf16_f32 v84, v104, v105
    buffer_load_dwordx4 a[4:7], v2, s[40:43], s12 offen offset:1024 sc0 sc1
    ds_write_b32 v82, v84 offset:14688
    v_pk_mul_f32 v[100:101], v[102:103], v[58:59] op_sel:[0,0] op_sel_hi:[1,0]
    v_pk_fma_f32 v[102:103], v[102:103], v[58:59], v[100:101] op_sel:[1,1,0] op_sel_hi:[0,1,1] neg_lo:[1,0,0]
    buffer_load_dwordx4 a[8:11], v2, s[40:43], s12 offen offset:2048 sc0 sc1
    v_pk_mul_f32 v[98:99], v[104:105], v[58:59] op_sel:[0,0] op_sel_hi:[1,0]
    v_pk_fma_f32 v[104:105], v[104:105], v[58:59], v[98:99] op_sel:[1,1,0] op_sel_hi:[0,1,1] neg_lo:[1,0,0]
    buffer_load_dwordx4 a[12:15], v2, s[40:43], s12 offen offset:3072 sc0 sc1
    v_cvt_pk_bf16_f32 v85, v102, v103
    ds_write_b32 v82, v85 offset:15232
    v_cvt_pk_bf16_f32 v86, v104, v105
    buffer_load_dwordx4 a[16:19], v2, s[40:43], s13 offen offset:0 sc0 sc1
    ds_write_b32 v82, v86 offset:15776
    v_pk_mul_f32 v[100:101], v[102:103], v[58:59] op_sel:[0,0] op_sel_hi:[1,0]
    v_pk_fma_f32 v[102:103], v[102:103], v[58:59], v[100:101] op_sel:[1,1,0] op_sel_hi:[0,1,1] neg_lo:[1,0,0]
    buffer_load_dwordx4 a[20:23], v2, s[40:43], s13 offen offset:1024 sc0 sc1
    v_pk_mul_f32 v[98:99], v[104:105], v[58:59] op_sel:[0,0] op_sel_hi:[1,0]
    v_pk_fma_f32 v[104:105], v[104:105], v[58:59], v[98:99] op_sel:[1,1,0] op_sel_hi:[0,1,1] neg_lo:[1,0,0]
    v_cvt_pk_bf16_f32 v87, v102, v103
    buffer_load_dwordx4 a[24:27], v2, s[40:43], s13 offen offset:2048 sc0 sc1
    ds_write_b32 v82, v87 offset:16320
    v_cvt_pk_bf16_f32 v84, v104, v105
    buffer_load_dwordx4 a[28:31], v2, s[40:43], s13 offen offset:3072 sc0 sc1
    ds_write_b32 v82, v84 offset:16864
    v_pk_mul_f32 v[100:101], v[60:61], v[78:79] op_sel:[0,0] op_sel_hi:[1,0]
    v_pk_fma_f32 v[106:107], v[60:61], v[78:79], v[100:101] op_sel:[1,1,0] op_sel_hi:[0,1,1] neg_lo:[1,0,0]
    buffer_load_dwordx4 a[32:35], v2, s[40:43], s14 offen offset:0 sc0 sc1
    v_pk_mul_f32 v[98:99], v[96:97], v[80:81] op_sel:[0,0] op_sel_hi:[1,0]
    v_pk_fma_f32 v[94:95], v[96:97], v[80:81], v[98:99] op_sel:[1,1,0] op_sel_hi:[0,1,1] neg_lo:[1,0,0]
    v_cvt_pk_bf16_f32 v85, v94, v95
    buffer_load_dwordx4 a[36:39], v2, s[40:43], s14 offen offset:1024 sc0 sc1
    ds_write_b32 v82, v85 offset:29920
    v_cvt_pk_bf16_f32 v86, v106, v107
    ds_write_b32 v82, v86 offset:17408
    v_pk_mul_f32 v[100:101], v[106:107], v[58:59] op_sel:[0,0] op_sel_hi:[1,0]
    v_pk_fma_f32 v[106:107], v[106:107], v[58:59], v[100:101] op_sel:[1,1,0] op_sel_hi:[0,1,1] neg_lo:[1,0,0]
    v_pk_mul_f32 v[98:99], v[94:95], v[80:81] op_sel:[0,0] op_sel_hi:[1,0]
    v_pk_fma_f32 v[96:97], v[94:95], v[80:81], v[98:99] op_sel:[1,1,0] op_sel_hi:[0,1,1] neg_lo:[1,0,0]
    v_cvt_pk_bf16_f32 v87, v96, v97
    ds_write_b32 v82, v87 offset:30464
    v_cvt_pk_bf16_f32 v84, v106, v107
    ds_write_b32 v82, v84 offset:17952
    v_pk_mul_f32 v[100:101], v[106:107], v[58:59] op_sel:[0,0] op_sel_hi:[1,0]
    v_pk_fma_f32 v[106:107], v[106:107], v[58:59], v[100:101] op_sel:[1,1,0] op_sel_hi:[0,1,1] neg_lo:[1,0,0]
    v_cvt_pk_bf16_f32 v85, v106, v107
    ds_write_b32 v82, v85 offset:18496
    v_pk_mul_f32 v[100:101], v[106:107], v[58:59] op_sel:[0,0] op_sel_hi:[1,0]
    v_pk_fma_f32 v[106:107], v[106:107], v[58:59], v[100:101] op_sel:[1,1,0] op_sel_hi:[0,1,1] neg_lo:[1,0,0]
    v_cvt_pk_bf16_f32 v86, v106, v107
    ds_write_b32 v82, v86 offset:19040
    v_pk_mul_f32 v[100:101], v[106:107], v[58:59] op_sel:[0,0] op_sel_hi:[1,0]
    v_pk_fma_f32 v[106:107], v[106:107], v[58:59], v[100:101] op_sel:[1,1,0] op_sel_hi:[0,1,1] neg_lo:[1,0,0]
    v_cvt_pk_bf16_f32 v87, v106, v107
    ds_write_b32 v82, v87 offset:19584
    v_pk_mul_f32 v[100:101], v[106:107], v[58:59] op_sel:[0,0] op_sel_hi:[1,0]
    v_pk_fma_f32 v[106:107], v[106:107], v[58:59], v[100:101] op_sel:[1,1,0] op_sel_hi:[0,1,1] neg_lo:[1,0,0]
    v_cvt_pk_bf16_f32 v84, v106, v107
    ds_write_b32 v82, v84 offset:20128
    v_pk_mul_f32 v[100:101], v[106:107], v[58:59] op_sel:[0,0] op_sel_hi:[1,0]
    v_pk_fma_f32 v[106:107], v[106:107], v[58:59], v[100:101] op_sel:[1,1,0] op_sel_hi:[0,1,1] neg_lo:[1,0,0]
    v_cvt_pk_bf16_f32 v85, v106, v107
    ds_write_b32 v82, v85 offset:20672
    v_pk_mul_f32 v[100:101], v[106:107], v[58:59] op_sel:[0,0] op_sel_hi:[1,0]
    v_pk_fma_f32 v[106:107], v[106:107], v[58:59], v[100:101] op_sel:[1,1,0] op_sel_hi:[0,1,1] neg_lo:[1,0,0]
    v_cvt_pk_bf16_f32 v86, v106, v107
    ds_write_b32 v82, v86 offset:21216
    v_pk_mul_f32 v[100:101], v[106:107], v[58:59] op_sel:[0,0] op_sel_hi:[1,0]
    v_pk_fma_f32 v[106:107], v[106:107], v[58:59], v[100:101] op_sel:[1,1,0] op_sel_hi:[0,1,1] neg_lo:[1,0,0]
    v_cvt_pk_bf16_f32 v87, v106, v107
    ds_write_b32 v82, v87 offset:21760
    s_mul_i32 s3, s82, 1392
    s_add_u32 s3, s3, 161024
    v_mov_b32 v108, 0
    v_mov_b32 v109, 0
    v_mov_b32 v110, 0
    v_mov_b32 v111, 0
    v_mov_b32_e64 v112, s3
    ds_write_b128 v112, v[108:111]
    v_and_b32 v64, 15, v1
    v_lshrrev_b32 v65, 4, v1
    v_mul_u32_u24 v66, 544, v64
    v_lshl_add_u32 v66, v65, 4, v66
    s_mul_i32 s70, s82, 31008
    s_add_u32 s70, s70, 81920
    v_add_u32 v66, s70, v66
    s_mul_i32 s70, s81, 8704
    v_add_u32 v67, s70, v66
    s_lshl_b32 s70, s70, 1
    v_add_u32 v68, s70, v66
    s_waitcnt lgkmcnt(0)
    s_barrier
    ds_read_b128 v[160:163], v66 offset:22304
    ds_read_b128 v[96:99], v67 offset:0
    ds_read_b128 v[128:131], v68 offset:0
    ds_read_b128 v[164:167], v66 offset:22368
    ds_read_b128 v[100:103], v67 offset:64
    ds_read_b128 v[132:135], v68 offset:64
    ds_read_b128 v[168:171], v66 offset:22432
    ds_read_b128 v[104:107], v67 offset:128
    ds_read_b128 v[136:139], v68 offset:128
    ds_read_b128 v[172:175], v66 offset:22496
    ds_read_b128 v[108:111], v67 offset:192
    ds_read_b128 v[140:143], v68 offset:192
    ds_read_b128 v[176:179], v66 offset:22560
    ds_read_b128 v[112:115], v67 offset:256
    ds_read_b128 v[144:147], v68 offset:256
    s_waitcnt lgkmcnt(12)
    v_mfma_f32_16x16x32_bf16 v[192:195], v[96:99], v[160:163], 0
    v_mfma_f32_16x16x32_bf16 v[196:199], v[128:131], v[160:163], 0
    ds_read_b128 v[180:183], v66 offset:22624
    ds_read_b128 v[116:119], v67 offset:320
    ds_read_b128 v[148:151], v68 offset:320
    s_waitcnt lgkmcnt(12)
    v_mfma_f32_16x16x32_bf16 v[192:195], v[100:103], v[164:167], v[192:195]
    v_mfma_f32_16x16x32_bf16 v[196:199], v[132:135], v[164:167], v[196:199]
    ds_read_b128 v[184:187], v66 offset:22688
    ds_read_b128 v[120:123], v67 offset:384
    ds_read_b128 v[152:155], v68 offset:384
    s_waitcnt lgkmcnt(12)
    v_mfma_f32_16x16x32_bf16 v[192:195], v[104:107], v[168:171], v[192:195]
    v_mfma_f32_16x16x32_bf16 v[196:199], v[136:139], v[168:171], v[196:199]
    ds_read_b128 v[188:191], v66 offset:22752
    ds_read_b128 v[124:127], v67 offset:448
    ds_read_b128 v[156:159], v68 offset:448
    s_waitcnt lgkmcnt(12)
    v_mfma_f32_16x16x32_bf16 v[192:195], v[108:111], v[172:175], v[192:195]
    v_mfma_f32_16x16x32_bf16 v[196:199], v[140:143], v[172:175], v[196:199]
    s_waitcnt lgkmcnt(9)
    v_mfma_f32_16x16x32_bf16 v[192:195], v[112:115], v[176:179], v[192:195]
    v_mfma_f32_16x16x32_bf16 v[196:199], v[144:147], v[176:179], v[196:199]
    s_waitcnt lgkmcnt(6)
    v_mfma_f32_16x16x32_bf16 v[192:195], v[116:119], v[180:183], v[192:195]
    v_mfma_f32_16x16x32_bf16 v[196:199], v[148:151], v[180:183], v[196:199]
    s_waitcnt lgkmcnt(3)
    v_mfma_f32_16x16x32_bf16 v[192:195], v[120:123], v[184:187], v[192:195]
    v_mfma_f32_16x16x32_bf16 v[196:199], v[152:155], v[184:187], v[196:199]
    s_waitcnt lgkmcnt(0)
    v_mfma_f32_16x16x32_bf16 v[192:195], v[124:127], v[188:191], v[192:195]
    v_mfma_f32_16x16x32_bf16 v[196:199], v[156:159], v[188:191], v[196:199]
    s_nop 7
    v_cvt_pk_bf16_f32 v90, v192, v193
    v_cvt_pk_bf16_f32 v91, v194, v195
    v_cvt_pk_bf16_f32 v92, v196, v197
    v_cvt_pk_bf16_f32 v93, v198, v199
    ds_write_b16 v245, v90
    s_nop 0
    ds_write_b16_d16_hi v246, v90
    ds_write_b16 v247, v91
    ds_write_b16_d16_hi v248, v91
    ds_write_b16 v249, v92
    ds_write_b16_d16_hi v250, v92
    ds_write_b16 v251, v93
    ds_write_b16_d16_hi v252, v93
    buffer_load_dwordx4 a[40:43], v2, s[40:43], s14 offen offset:2048 sc0 sc1
    buffer_load_dwordx4 a[44:47], v2, s[40:43], s14 offen offset:3072 sc0 sc1
    buffer_load_dwordx4 a[48:51], v2, s[40:43], s15 offen offset:0 sc0 sc1
    buffer_load_dwordx4 a[52:55], v2, s[40:43], s15 offen offset:1024 sc0 sc1
    buffer_load_dwordx4 a[56:59], v2, s[40:43], s15 offen offset:2048 sc0 sc1
    buffer_load_dwordx4 a[60:63], v2, s[40:43], s15 offen offset:3072 sc0 sc1
    ds_read_b64_tr_b16 v[204:205], v200 offset:0
    ds_read_b64_tr_b16 v[206:207], v200 offset:1024
    ds_read_b64_tr_b16 v[208:209], v201 offset:0
    ds_read_b64_tr_b16 v[210:211], v201 offset:1024
    s_waitcnt lgkmcnt(0)
    buffer_store_dwordx4 v[204:207], v2, s[40:43], s50 offen offset:0 sc0 sc1
    buffer_store_dwordx4 v[208:211], v2, s[40:43], s50 offen offset:1024 sc0 sc1
    v_lshrrev_b32 v30, 4, v1
    v_and_b32 v31, 1, v30
    v_lshrrev_b32 v30, 1, v30
    v_bfe_u32 v64, v1, 2, 2
    v_lshl_add_u32 v30, v30, 3, v64
    v_lshrrev_b32 v64, 1, v64
    v_lshlrev_b32 v64, 1, v64
    v_xor_b32 v64, v64, v31
    v_and_b32 v65, 3, v1
    v_lshlrev_b32_e64 v65, 3, v65
    v_lshl_add_u32 v66, v30, 7, v65
    v_lshl_add_u32 v66, v31, 13, v66
    v_xor_b32_e64 v67, 0, v64
    v_lshl_add_u32 v4, v67, 5, v66
    v_xor_b32_e64 v67, 1, v64
    v_lshl_add_u32 v5, v67, 5, v66
    v_xor_b32_e64 v67, 2, v64
    v_lshl_add_u32 v6, v67, 5, v66
    v_xor_b32_e64 v67, 3, v64
    v_lshl_add_u32 v7, v67, 5, v66
    v_mul_u32_u24 v30, 96, v30
    v_add_u32_e64 v30, v30, v65
    v_mul_u32_u24 v31, 6272, v31
    v_add_u32_e64 v28, v30, v31
    v_add_u32 v27, 131072, v28
    v_add_u32 v29, 0x10000, v28
    s_waitcnt lgkmcnt(0)
    s_barrier
    s_add_u32 s93, s93, 12288
    s_lshl_b32 s92, s64, 8
    s_lshl_b32 s72, s65, 2
    s_add_u32 s92, s92, s72
    s_add_u32 s92, s92, 20480
    s_mov_b32 s86, 0xbdd2d3e8
    s_mov_b32 s87, 0xbdd2d3e8
    s_nop 0
    v_mov_b32 v120, 0xc0135761
    v_mov_b32 v121, 0xc0135761
    ds_read_b64_tr_b16 v[32:33], v4 offset:0
    ds_read_b64_tr_b16 v[34:35], v4 offset:512
    ds_read_b64_tr_b16 v[36:37], v5 offset:0
    ds_read_b64_tr_b16 v[38:39], v5 offset:512
    ds_read_b64_tr_b16 v[40:41], v6 offset:0
    ds_read_b64_tr_b16 v[42:43], v6 offset:512
    ds_read_b64_tr_b16 v[44:45], v7 offset:0
    ds_read_b64_tr_b16 v[46:47], v7 offset:512
    ds_read_b64_tr_b16 v[48:49], v4 offset:2048
    ds_read_b64_tr_b16 v[50:51], v4 offset:2560
    ds_read_b64_tr_b16 v[52:53], v5 offset:2048
    ds_read_b64_tr_b16 v[54:55], v5 offset:2560
    ds_read_b64_tr_b16 v[56:57], v6 offset:2048
    ds_read_b64_tr_b16 v[58:59], v6 offset:2560
    ds_read_b64_tr_b16 v[60:61], v7 offset:2048
    ds_read_b64_tr_b16 v[62:63], v7 offset:2560
    s_waitcnt vmcnt(17)
    s_waitcnt lgkmcnt(12)
    v_mfma_f32_32x32x16_bf16 v[128:143], v[32:35], a[0:3], 0
    ds_read_b64_tr_b16 v[32:33], v4 offset:4096
    ds_read_b64_tr_b16 v[34:35], v4 offset:4608
    v_mfma_f32_32x32x16_bf16 v[144:159], v[36:39], a[0:3], 0
    ds_read_b64_tr_b16 v[36:37], v5 offset:4096
    ds_read_b64_tr_b16 v[38:39], v5 offset:4608
    buffer_load_dwordx4 a[64:67], v2, s[40:43], s16 offen offset:0 sc0 sc1
    s_add_u32 m0, s79, 81920
    s_waitcnt lgkmcnt(12)
    v_mfma_f32_32x32x16_bf16 v[160:175], v[40:43], a[0:3], 0
    ds_read_b64_tr_b16 v[40:41], v6 offset:4096
    ds_read_b64_tr_b16 v[42:43], v6 offset:4608
    s_add_u32 s34, s9, 0
    v_mfma_f32_32x32x16_bf16 v[176:191], v[44:47], a[0:3], 0
    ds_read_b64_tr_b16 v[44:45], v7 offset:4096
    ds_read_b64_tr_b16 v[46:47], v7 offset:4608
    buffer_load_dwordx4 v22, s[44:47], s34 offen lds
    s_waitcnt vmcnt(18)
    s_waitcnt lgkmcnt(12)
    v_mfma_f32_32x32x16_bf16 v[128:143], v[48:51], a[4:7], v[128:143]
    ds_read_b64_tr_b16 v[48:49], v4 offset:6144
    ds_read_b64_tr_b16 v[50:51], v4 offset:6656
    s_lshl_b32 s3, s81, 6
    v_mfma_f32_32x32x16_bf16 v[144:159], v[52:55], a[4:7], v[144:159]
    ds_read_b64_tr_b16 v[52:53], v5 offset:6144
    ds_read_b64_tr_b16 v[54:55], v5 offset:6656
    s_add_u32 m0, s79, 82944
    v_add_u32 v112, s3, v1
    s_waitcnt lgkmcnt(12)
    v_mfma_f32_32x32x16_bf16 v[160:175], v[56:59], a[4:7], v[160:175]
    ds_read_b64_tr_b16 v[56:57], v6 offset:6144
    ds_read_b64_tr_b16 v[58:59], v6 offset:6656
    s_add_u32 s34, s9, 28672
    v_lshlrev_b32 v113, 4, v112
    v_mfma_f32_32x32x16_bf16 v[176:191], v[60:63], a[4:7], v[176:191]
    ds_read_b64_tr_b16 v[60:61], v7 offset:6144
    ds_read_b64_tr_b16 v[62:63], v7 offset:6656
    buffer_load_dwordx4 v22, s[44:47], s34 offen lds
    s_mul_i32 s48, s82, 1392
    s_waitcnt vmcnt(18)
    s_waitcnt lgkmcnt(12)
    v_mfma_f32_32x32x16_bf16 v[128:143], v[32:35], a[8:11], v[128:143]
    ds_read_b64_tr_b16 v[32:33], v4 offset:16384
    ds_read_b64_tr_b16 v[34:35], v4 offset:16896
    s_add_u32 s48, s48, 126992
    v_mfma_f32_32x32x16_bf16 v[144:159], v[36:39], a[8:11], v[144:159]
    ds_read_b64_tr_b16 v[36:37], v5 offset:16384
    ds_read_b64_tr_b16 v[38:39], v5 offset:16896
    s_add_u32 m0, s79, 83968
    v_subrev_u32 v114, 8, v113
    s_add_u32 s34, s9, 57344
    s_waitcnt lgkmcnt(12)
    v_mfma_f32_32x32x16_bf16 v[160:175], v[40:43], a[8:11], v[160:175]
    ds_read_b64_tr_b16 v[40:41], v6 offset:16384
    ds_read_b64_tr_b16 v[42:43], v6 offset:16896
    v_cvt_f32_i32 v115, v114
    v_mfma_f32_32x32x16_bf16 v[176:191], v[44:47], a[8:11], v[176:191]
    ds_read_b64_tr_b16 v[44:45], v7 offset:16384
    ds_read_b64_tr_b16 v[46:47], v7 offset:16896
    buffer_load_dwordx4 v22, s[44:47], s34 offen lds
    v_add_u32 v114, 17024, v114
    s_waitcnt vmcnt(18)
    s_waitcnt lgkmcnt(12)
    v_mfma_f32_32x32x16_bf16 v[128:143], v[48:51], a[12:15], v[128:143]
    ds_read_b64_tr_b16 v[48:49], v4 offset:18432
    ds_read_b64_tr_b16 v[50:51], v4 offset:18944
    s_add_u32 m0, s79, 84992
    v_mfma_f32_32x32x16_bf16 v[144:159], v[52:55], a[12:15], v[144:159]
    ds_read_b64_tr_b16 v[52:53], v5 offset:18432
    ds_read_b64_tr_b16 v[54:55], v5 offset:18944
    v_mov_b32 v122, 17152
    s_add_u32 s34, s9, 86016
    v_add_f32 v116, 0x40800000, v115
    s_waitcnt lgkmcnt(12)
    v_mfma_f32_32x32x16_bf16 v[160:175], v[56:59], a[12:15], v[160:175]
    ds_read_b64_tr_b16 v[56:57], v6 offset:18432
    ds_read_b64_tr_b16 v[58:59], v6 offset:18944
    v_add_f32 v117, 0x40a00000, v115
    v_mfma_f32_32x32x16_bf16 v[176:191], v[60:63], a[12:15], v[176:191]
    ds_read_b64_tr_b16 v[60:61], v7 offset:18432
    ds_read_b64_tr_b16 v[62:63], v7 offset:18944
    buffer_load_dwordx4 v22, s[44:47], s34 offen lds
    v_cvt_pk_bf16_f32 v116, v116, v117
    s_waitcnt vmcnt(18)
    s_waitcnt lgkmcnt(12)
    v_mfma_f32_32x32x16_bf16 v[128:143], v[32:35], a[16:19], v[128:143]
    ds_read_b64_tr_b16 v[32:33], v4 offset:20480
    ds_read_b64_tr_b16 v[34:35], v4 offset:20992
    v_bfe_i32 v117, v116, 0, 16
    v_mfma_f32_32x32x16_bf16 v[144:159], v[36:39], a[16:19], v[144:159]
    ds_read_b64_tr_b16 v[36:37], v5 offset:20480
    ds_read_b64_tr_b16 v[38:39], v5 offset:20992
    buffer_load_dwordx4 a[68:71], v2, s[40:43], s16 offen offset:1024 sc0 sc1
    v_ashrrev_i32 v116, 16, v116
    s_waitcnt lgkmcnt(12)
    v_mfma_f32_32x32x16_bf16 v[160:175], v[40:43], a[16:19], v[160:175]
    ds_read_b64_tr_b16 v[40:41], v6 offset:20480
    ds_read_b64_tr_b16 v[42:43], v6 offset:20992
    v_add_u32 v118, 4, v114
    v_mfma_f32_32x32x16_bf16 v[176:191], v[44:47], a[16:19], v[176:191]
    ds_read_b64_tr_b16 v[44:45], v7 offset:20480
    ds_read_b64_tr_b16 v[46:47], v7 offset:20992
    buffer_load_dwordx4 a[72:75], v2, s[40:43], s16 offen offset:2048 sc0 sc1
    v_add_u32 v119, 5, v114
    s_waitcnt vmcnt(19)
    s_waitcnt lgkmcnt(12)
    v_mfma_f32_32x32x16_bf16 v[128:143], v[48:51], a[20:23], v[128:143]
    ds_read_b64_tr_b16 v[48:49], v4 offset:22528
    ds_read_b64_tr_b16 v[50:51], v4 offset:23040
    v_med3_i32 v117, v118, v117, v122
    v_mfma_f32_32x32x16_bf16 v[144:159], v[52:55], a[20:23], v[144:159]
    ds_read_b64_tr_b16 v[52:53], v5 offset:22528
    ds_read_b64_tr_b16 v[54:55], v5 offset:23040
    buffer_load_dwordx4 a[76:79], v2, s[40:43], s16 offen offset:3072 sc0 sc1
    v_med3_i32 v116, v119, v116, v122
    s_waitcnt lgkmcnt(12)
    v_mfma_f32_32x32x16_bf16 v[160:175], v[56:59], a[20:23], v[160:175]
    ds_read_b64_tr_b16 v[56:57], v6 offset:22528
    ds_read_b64_tr_b16 v[58:59], v6 offset:23040
    v_lshl_add_u32 v92, v117, 1, s48
    v_mfma_f32_32x32x16_bf16 v[176:191], v[60:63], a[20:23], v[176:191]
    ds_read_b64_tr_b16 v[60:61], v7 offset:22528
    ds_read_b64_tr_b16 v[62:63], v7 offset:23040
    buffer_load_dwordx4 a[80:83], v2, s[40:43], s17 offen offset:0 sc0 sc1
    s_add_u32 m0, s79, 98304
    s_waitcnt vmcnt(20)
    s_waitcnt lgkmcnt(12)
    v_mfma_f32_32x32x16_bf16 v[128:143], v[32:35], a[24:27], v[128:143]
    ds_read_b64_tr_b16 v[32:33], v4 offset:32768
    ds_read_b64_tr_b16 v[34:35], v4 offset:33280
    s_add_u32 s34, s10, 0
    v_mfma_f32_32x32x16_bf16 v[144:159], v[36:39], a[24:27], v[144:159]
    ds_read_b64_tr_b16 v[36:37], v5 offset:32768
    ds_read_b64_tr_b16 v[38:39], v5 offset:33280
    buffer_load_dwordx4 v22, s[44:47], s34 offen lds
    s_add_u32 m0, s79, 99328
    s_waitcnt lgkmcnt(12)
    v_mfma_f32_32x32x16_bf16 v[160:175], v[40:43], a[24:27], v[160:175]
    ds_read_b64_tr_b16 v[40:41], v6 offset:32768
    ds_read_b64_tr_b16 v[42:43], v6 offset:33280
    v_lshl_add_u32 v93, v116, 1, s48
    v_add_f32 v116, 0x40c00000, v115
    v_mfma_f32_32x32x16_bf16 v[176:191], v[44:47], a[24:27], v[176:191]
    ds_read_b64_tr_b16 v[44:45], v7 offset:32768
    ds_read_b64_tr_b16 v[46:47], v7 offset:33280
    s_add_u32 s34, s10, 28672
    v_add_f32 v117, 0x40e00000, v115
    v_cvt_pk_bf16_f32 v116, v116, v117
    s_waitcnt vmcnt(20)
    s_waitcnt lgkmcnt(12)
    v_mfma_f32_32x32x16_bf16 v[128:143], v[48:51], a[28:31], v[128:143]
    ds_read_b64_tr_b16 v[48:49], v4 offset:34816
    ds_read_b64_tr_b16 v[50:51], v4 offset:35328
    v_bfe_i32 v117, v116, 0, 16
    v_mfma_f32_32x32x16_bf16 v[144:159], v[52:55], a[28:31], v[144:159]
    ds_read_b64_tr_b16 v[52:53], v5 offset:34816
    ds_read_b64_tr_b16 v[54:55], v5 offset:35328
    buffer_load_dwordx4 v22, s[44:47], s34 offen lds
    s_add_u32 m0, s79, 100352
    s_waitcnt lgkmcnt(12)
    v_mfma_f32_32x32x16_bf16 v[160:175], v[56:59], a[28:31], v[160:175]
    ds_read_b64_tr_b16 v[56:57], v6 offset:34816
    ds_read_b64_tr_b16 v[58:59], v6 offset:35328
    s_add_u32 s34, s10, 57344
    v_ashrrev_i32 v116, 16, v116
    v_mfma_f32_32x32x16_bf16 v[176:191], v[60:63], a[28:31], v[176:191]
    ds_read_b64_tr_b16 v[60:61], v7 offset:34816
    ds_read_b64_tr_b16 v[62:63], v7 offset:35328
    buffer_load_dwordx4 v22, s[44:47], s34 offen lds
    v_add_u32 v118, 6, v114
    s_waitcnt vmcnt(21)
    s_waitcnt lgkmcnt(12)
    v_mfma_f32_32x32x16_bf16 v[128:143], v[32:35], a[32:35], v[128:143]
    ds_read_b64_tr_b16 v[32:33], v4 offset:36864
    ds_read_b64_tr_b16 v[34:35], v4 offset:37376
    v_add_u32 v119, 7, v114
    v_mfma_f32_32x32x16_bf16 v[144:159], v[36:39], a[32:35], v[144:159]
    ds_read_b64_tr_b16 v[36:37], v5 offset:36864
    ds_read_b64_tr_b16 v[38:39], v5 offset:37376
    s_add_u32 m0, s79, 101376
    v_med3_i32 v117, v118, v117, v122
    s_add_u32 s34, s10, 86016
    s_waitcnt lgkmcnt(12)
    v_mfma_f32_32x32x16_bf16 v[160:175], v[40:43], a[32:35], v[160:175]
    ds_read_b64_tr_b16 v[40:41], v6 offset:36864
    ds_read_b64_tr_b16 v[42:43], v6 offset:37376
    v_med3_i32 v116, v119, v116, v122
    v_lshl_add_u32 v94, v117, 1, s48
    v_mfma_f32_32x32x16_bf16 v[176:191], v[44:47], a[32:35], v[176:191]
    ds_read_b64_tr_b16 v[44:45], v7 offset:36864
    ds_read_b64_tr_b16 v[46:47], v7 offset:37376
    buffer_load_dwordx4 v22, s[44:47], s34 offen lds
    v_lshl_add_u32 v95, v116, 1, s48
    s_waitcnt vmcnt(21)
    s_waitcnt lgkmcnt(12)
    v_mfma_f32_32x32x16_bf16 v[128:143], v[48:51], a[36:39], v[128:143]
    ds_read_b64_tr_b16 v[48:49], v4 offset:38912
    ds_read_b64_tr_b16 v[50:51], v4 offset:39424
    v_add_f32 v116, 0x41000000, v115
    v_mfma_f32_32x32x16_bf16 v[144:159], v[52:55], a[36:39], v[144:159]
    ds_read_b64_tr_b16 v[52:53], v5 offset:38912
    ds_read_b64_tr_b16 v[54:55], v5 offset:39424
    buffer_load_dwordx4 a[84:87], v2, s[40:43], s17 offen offset:1024 sc0 sc1
    v_add_f32 v117, 0x41100000, v115
    s_waitcnt lgkmcnt(12)
    v_mfma_f32_32x32x16_bf16 v[160:175], v[56:59], a[36:39], v[160:175]
    ds_read_b64_tr_b16 v[56:57], v6 offset:38912
    ds_read_b64_tr_b16 v[58:59], v6 offset:39424
    v_cvt_pk_bf16_f32 v116, v116, v117
    v_bfe_i32 v117, v116, 0, 16
    v_mfma_f32_32x32x16_bf16 v[176:191], v[60:63], a[36:39], v[176:191]
    ds_read_b64_tr_b16 v[60:61], v7 offset:38912
    ds_read_b64_tr_b16 v[62:63], v7 offset:39424
    buffer_load_dwordx4 a[88:91], v2, s[40:43], s17 offen offset:2048 sc0 sc1
    v_ashrrev_i32 v116, 16, v116
    s_waitcnt vmcnt(22)
    s_waitcnt lgkmcnt(12)
    v_mfma_f32_32x32x16_bf16 v[128:143], v[32:35], a[40:43], v[128:143]
    ds_read_b64_tr_b16 v[32:33], v4 offset:49152
    ds_read_b64_tr_b16 v[34:35], v4 offset:49664
    v_add_u32 v118, 8, v114
    v_mfma_f32_32x32x16_bf16 v[144:159], v[36:39], a[40:43], v[144:159]
    ds_read_b64_tr_b16 v[36:37], v5 offset:49152
    ds_read_b64_tr_b16 v[38:39], v5 offset:49664
    buffer_load_dwordx4 a[92:95], v2, s[40:43], s17 offen offset:3072 sc0 sc1
    v_add_u32 v119, 9, v114
    s_waitcnt lgkmcnt(12)
    v_mfma_f32_32x32x16_bf16 v[160:175], v[40:43], a[40:43], v[160:175]
    ds_read_b64_tr_b16 v[40:41], v6 offset:49152
    ds_read_b64_tr_b16 v[42:43], v6 offset:49664
    v_med3_i32 v117, v118, v117, v122
    v_mfma_f32_32x32x16_bf16 v[176:191], v[44:47], a[40:43], v[176:191]
    ds_read_b64_tr_b16 v[44:45], v7 offset:49152
    ds_read_b64_tr_b16 v[46:47], v7 offset:49664
    buffer_load_dwordx4 a[96:99], v2, s[40:43], s18 offen offset:0 sc0 sc1
    s_add_u32 m0, s79, 114688
    s_waitcnt vmcnt(23)
    s_waitcnt lgkmcnt(12)
    v_mfma_f32_32x32x16_bf16 v[128:143], v[48:51], a[44:47], v[128:143]
    ds_read_b64_tr_b16 v[48:49], v4 offset:51200
    ds_read_b64_tr_b16 v[50:51], v4 offset:51712
    s_add_u32 s34, s11, 0
    v_mfma_f32_32x32x16_bf16 v[144:159], v[52:55], a[44:47], v[144:159]
    ds_read_b64_tr_b16 v[52:53], v5 offset:51200
    ds_read_b64_tr_b16 v[54:55], v5 offset:51712
    buffer_load_dwordx4 v22, s[44:47], s34 offen lds
    s_add_u32 m0, s79, 115712
    s_waitcnt lgkmcnt(12)
    v_mfma_f32_32x32x16_bf16 v[160:175], v[56:59], a[44:47], v[160:175]
    ds_read_b64_tr_b16 v[56:57], v6 offset:51200
    ds_read_b64_tr_b16 v[58:59], v6 offset:51712
    s_add_u32 s34, s11, 28672
    v_med3_i32 v116, v119, v116, v122
    v_mfma_f32_32x32x16_bf16 v[176:191], v[60:63], a[44:47], v[176:191]
    ds_read_b64_tr_b16 v[60:61], v7 offset:51200
    ds_read_b64_tr_b16 v[62:63], v7 offset:51712
    v_lshl_add_u32 v96, v117, 1, s48
    buffer_load_dwordx4 v22, s[44:47], s34 offen lds
    s_waitcnt vmcnt(24)
    s_waitcnt lgkmcnt(12)
    v_mfma_f32_32x32x16_bf16 v[128:143], v[32:35], a[48:51], v[128:143]
    ds_read_b64_tr_b16 v[32:33], v4 offset:53248
    ds_read_b64_tr_b16 v[34:35], v4 offset:53760
    v_lshl_add_u32 v97, v116, 1, s48
    v_mfma_f32_32x32x16_bf16 v[144:159], v[36:39], a[48:51], v[144:159]
    ds_read_b64_tr_b16 v[36:37], v5 offset:53248
    ds_read_b64_tr_b16 v[38:39], v5 offset:53760
    s_add_u32 m0, s79, 116736
    v_add_f32 v116, 0x41200000, v115
    s_add_u32 s34, s11, 57344
    s_waitcnt lgkmcnt(12)
    v_mfma_f32_32x32x16_bf16 v[160:175], v[40:43], a[48:51], v[160:175]
    ds_read_b64_tr_b16 v[40:41], v6 offset:53248
    ds_read_b64_tr_b16 v[42:43], v6 offset:53760
    v_add_f32 v117, 0x41300000, v115
    v_cvt_pk_bf16_f32 v116, v116, v117
    v_mfma_f32_32x32x16_bf16 v[176:191], v[44:47], a[48:51], v[176:191]
    ds_read_b64_tr_b16 v[44:45], v7 offset:53248
    ds_read_b64_tr_b16 v[46:47], v7 offset:53760
    buffer_load_dwordx4 v22, s[44:47], s34 offen lds
    v_bfe_i32 v117, v116, 0, 16
    s_waitcnt vmcnt(24)
    s_waitcnt lgkmcnt(12)
    v_mfma_f32_32x32x16_bf16 v[128:143], v[48:51], a[52:55], v[128:143]
    ds_read_b64_tr_b16 v[48:49], v4 offset:55296
    ds_read_b64_tr_b16 v[50:51], v4 offset:55808
    s_add_u32 m0, s79, 117760
    v_mfma_f32_32x32x16_bf16 v[144:159], v[52:55], a[52:55], v[144:159]
    ds_read_b64_tr_b16 v[52:53], v5 offset:55296
    ds_read_b64_tr_b16 v[54:55], v5 offset:55808
    v_ashrrev_i32 v116, 16, v116
    s_add_u32 s34, s11, 86016
    v_add_u32 v118, 10, v114
    s_waitcnt lgkmcnt(12)
    v_mfma_f32_32x32x16_bf16 v[160:175], v[56:59], a[52:55], v[160:175]
    ds_read_b64_tr_b16 v[56:57], v6 offset:55296
    ds_read_b64_tr_b16 v[58:59], v6 offset:55808
    buffer_load_dwordx4 v22, s[44:47], s34 offen lds
    v_mfma_f32_32x32x16_bf16 v[176:191], v[60:63], a[52:55], v[176:191]
    ds_read_b64_tr_b16 v[60:61], v7 offset:55296
    ds_read_b64_tr_b16 v[62:63], v7 offset:55808
    v_add_u32 v119, 11, v114
    v_med3_i32 v117, v118, v117, v122
    v_med3_i32 v116, v119, v116, v122
    s_waitcnt vmcnt(24)
    s_waitcnt lgkmcnt(12)
    v_mfma_f32_32x32x16_bf16 v[128:143], v[32:35], a[56:59], v[128:143]
    v_add_u32 v4, 0x10000, v4
    ds_read_b64_tr_b16 v[32:33], v4 offset:0
    ds_read_b64_tr_b16 v[34:35], v4 offset:512
    v_mfma_f32_32x32x16_bf16 v[144:159], v[36:39], a[56:59], v[144:159]
    v_add_u32 v5, 0x10000, v5
    ds_read_b64_tr_b16 v[36:37], v5 offset:0
    ds_read_b64_tr_b16 v[38:39], v5 offset:512
    buffer_load_dwordx4 a[100:103], v2, s[40:43], s18 offen offset:1024 sc0 sc1
    s_waitcnt lgkmcnt(12)
    v_mfma_f32_32x32x16_bf16 v[160:175], v[40:43], a[56:59], v[160:175]
    v_add_u32 v6, 0x10000, v6
    ds_read_b64_tr_b16 v[40:41], v6 offset:0
    ds_read_b64_tr_b16 v[42:43], v6 offset:512
    v_lshl_add_u32 v98, v117, 1, s48
    v_mfma_f32_32x32x16_bf16 v[176:191], v[44:47], a[56:59], v[176:191]
    v_add_u32 v7, 0x10000, v7
    ds_read_b64_tr_b16 v[44:45], v7 offset:0
    ds_read_b64_tr_b16 v[46:47], v7 offset:512
    buffer_load_dwordx4 a[104:107], v2, s[40:43], s18 offen offset:2048 sc0 sc1
    s_waitcnt vmcnt(25)
    s_waitcnt lgkmcnt(12)
    v_mfma_f32_32x32x16_bf16 v[128:143], v[48:51], a[60:63], v[128:143]
    ds_read_b64_tr_b16 v[48:49], v4 offset:2048
    ds_read_b64_tr_b16 v[50:51], v4 offset:2560
    v_lshl_add_u32 v99, v116, 1, s48
    v_mfma_f32_32x32x16_bf16 v[144:159], v[52:55], a[60:63], v[144:159]
    ds_read_b64_tr_b16 v[52:53], v5 offset:2048
    ds_read_b64_tr_b16 v[54:55], v5 offset:2560
    buffer_load_dwordx4 a[108:111], v2, s[40:43], s18 offen offset:3072 sc0 sc1
    v_add_f32 v116, 0x41400000, v115
    s_waitcnt lgkmcnt(12)
    v_mfma_f32_32x32x16_bf16 v[160:175], v[56:59], a[60:63], v[160:175]
    ds_read_b64_tr_b16 v[56:57], v6 offset:2048
    ds_read_b64_tr_b16 v[58:59], v6 offset:2560
    v_add_f32 v117, 0x41500000, v115
    v_cvt_pk_bf16_f32 v116, v116, v117
    v_mfma_f32_32x32x16_bf16 v[176:191], v[60:63], a[60:63], v[176:191]
    ds_read_b64_tr_b16 v[60:61], v7 offset:2048
    ds_read_b64_tr_b16 v[62:63], v7 offset:2560
    buffer_load_dwordx4 a[112:115], v2, s[40:43], s19 offen offset:0 sc0 sc1
    s_add_u32 m0, s83, 131072
    s_waitcnt vmcnt(24)
    s_waitcnt lgkmcnt(12)
    v_mfma_f32_32x32x16_bf16 v[128:143], v[32:35], a[64:67], v[128:143]
    ds_read_b64_tr_b16 v[32:33], v4 offset:4096
    ds_read_b64_tr_b16 v[34:35], v4 offset:4608
    s_add_u32 s34, s4, s35
    v_bfe_i32 v117, v116, 0, 16
    v_mfma_f32_32x32x16_bf16 v[144:159], v[36:39], a[64:67], v[144:159]
    ds_read_b64_tr_b16 v[36:37], v5 offset:4096
    ds_read_b64_tr_b16 v[38:39], v5 offset:4608
    buffer_load_dwordx4 v23, s[44:47], s34 offen lds
    s_add_u32 m0, s83, 132096
    v_ashrrev_i32 v116, 16, v116
    s_waitcnt lgkmcnt(12)
    v_mfma_f32_32x32x16_bf16 v[160:175], v[40:43], a[64:67], v[160:175]
    ds_read_b64_tr_b16 v[40:41], v6 offset:4096
    ds_read_b64_tr_b16 v[42:43], v6 offset:4608
    s_add_u32 s34, s4, s35
    v_add_u32 v118, 12, v114
    v_mfma_f32_32x32x16_bf16 v[176:191], v[44:47], a[64:67], v[176:191]
    ds_read_b64_tr_b16 v[44:45], v7 offset:4096
    ds_read_b64_tr_b16 v[46:47], v7 offset:4608
    v_add_u32 v119, 13, v114
    v_med3_i32 v117, v118, v117, v122
    v_med3_i32 v116, v119, v116, v122
    s_waitcnt vmcnt(21)
    s_barrier
    s_add_u32 s99, s93, s69
    v_mov_b32 v254, s99
    v_mov_b32 v255, s68
    s_mov_b64 exec, 1
    buffer_store_dword v255, v254, s[40:43], 0 offen sc0 sc1
    s_mov_b64 exec, -1
    s_waitcnt vmcnt(21)
    s_waitcnt lgkmcnt(12)
    v_mfma_f32_32x32x16_bf16 v[128:143], v[48:51], a[68:71], v[128:143]
    ds_read_b64_tr_b16 v[48:49], v4 offset:6144
    ds_read_b64_tr_b16 v[50:51], v4 offset:6656
    v_mfma_f32_32x32x16_bf16 v[144:159], v[52:55], a[68:71], v[144:159]
    ds_read_b64_tr_b16 v[52:53], v5 offset:6144
    ds_read_b64_tr_b16 v[54:55], v5 offset:6656
    buffer_load_dwordx4 v24, s[44:47], s34 offen lds
    s_add_u32 m0, s83, 133120
    s_waitcnt lgkmcnt(12)
    v_mfma_f32_32x32x16_bf16 v[160:175], v[56:59], a[68:71], v[160:175]
    ds_read_b64_tr_b16 v[56:57], v6 offset:6144
    ds_read_b64_tr_b16 v[58:59], v6 offset:6656
    s_add_u32 s34, s4, s35
    v_lshl_add_u32 v100, v117, 1, s48
    v_mfma_f32_32x32x16_bf16 v[176:191], v[60:63], a[68:71], v[176:191]
    ds_read_b64_tr_b16 v[60:61], v7 offset:6144
    ds_read_b64_tr_b16 v[62:63], v7 offset:6656
    v_lshl_add_u32 v101, v116, 1, s48
    v_add_f32 v116, 0x41600000, v115
    v_add_f32 v117, 0x41700000, v115
    s_waitcnt vmcnt(21)
    s_waitcnt lgkmcnt(12)
    v_mfma_f32_32x32x16_bf16 v[128:143], v[32:35], a[72:75], v[128:143]
    ds_read_b64_tr_b16 v[32:33], v4 offset:16384
    ds_read_b64_tr_b16 v[34:35], v4 offset:16896
    v_cvt_pk_bf16_f32 v116, v116, v117
    v_mfma_f32_32x32x16_bf16 v[144:159], v[36:39], a[72:75], v[144:159]
    ds_read_b64_tr_b16 v[36:37], v5 offset:16384
    ds_read_b64_tr_b16 v[38:39], v5 offset:16896
    buffer_load_dwordx4 v25, s[44:47], s34 offen lds
    s_add_u32 m0, s83, 143488
    s_waitcnt lgkmcnt(12)
    v_mfma_f32_32x32x16_bf16 v[160:175], v[40:43], a[72:75], v[160:175]
    ds_read_b64_tr_b16 v[40:41], v6 offset:16384
    ds_read_b64_tr_b16 v[42:43], v6 offset:16896
    s_add_u32 s34, s5, s35
    v_bfe_i32 v117, v116, 0, 16
    v_mfma_f32_32x32x16_bf16 v[176:191], v[44:47], a[72:75], v[176:191]
    ds_read_b64_tr_b16 v[44:45], v7 offset:16384
    ds_read_b64_tr_b16 v[46:47], v7 offset:16896
    v_ashrrev_i32 v116, 16, v116
    v_add_u32 v118, 14, v114
    v_add_u32 v119, 15, v114
    s_waitcnt vmcnt(21)
    s_waitcnt lgkmcnt(12)
    v_mfma_f32_32x32x16_bf16 v[128:143], v[48:51], a[76:79], v[128:143]
    ds_read_b64_tr_b16 v[48:49], v4 offset:18432
    ds_read_b64_tr_b16 v[50:51], v4 offset:18944
    v_med3_i32 v117, v118, v117, v122
    v_mfma_f32_32x32x16_bf16 v[144:159], v[52:55], a[76:79], v[144:159]
    ds_read_b64_tr_b16 v[52:53], v5 offset:18432
    ds_read_b64_tr_b16 v[54:55], v5 offset:18944
    buffer_load_dwordx4 v23, s[44:47], s34 offen lds
    s_add_u32 m0, s83, 144512
    s_waitcnt lgkmcnt(12)
    v_mfma_f32_32x32x16_bf16 v[160:175], v[56:59], a[76:79], v[160:175]
    ds_read_b64_tr_b16 v[56:57], v6 offset:18432
    ds_read_b64_tr_b16 v[58:59], v6 offset:18944
    s_add_u32 s34, s5, s35
    v_med3_i32 v116, v119, v116, v122
    v_mfma_f32_32x32x16_bf16 v[176:191], v[60:63], a[76:79], v[176:191]
    ds_read_b64_tr_b16 v[60:61], v7 offset:18432
    ds_read_b64_tr_b16 v[62:63], v7 offset:18944
    v_lshl_add_u32 v102, v117, 1, s48
    v_lshl_add_u32 v103, v116, 1, s48
    v_add_f32 v116, 0x41800000, v115
    s_waitcnt vmcnt(21)
    s_waitcnt lgkmcnt(12)
    v_mfma_f32_32x32x16_bf16 v[128:143], v[32:35], a[80:83], v[128:143]
    ds_read_b64_tr_b16 v[32:33], v4 offset:20480
    ds_read_b64_tr_b16 v[34:35], v4 offset:20992
    v_add_f32 v117, 0x41880000, v115
    v_mfma_f32_32x32x16_bf16 v[144:159], v[36:39], a[80:83], v[144:159]
    ds_read_b64_tr_b16 v[36:37], v5 offset:20480
    ds_read_b64_tr_b16 v[38:39], v5 offset:20992
    buffer_load_dwordx4 v24, s[44:47], s34 offen lds
    s_add_u32 m0, s83, 145536
    s_waitcnt lgkmcnt(12)
    v_mfma_f32_32x32x16_bf16 v[160:175], v[40:43], a[80:83], v[160:175]
    ds_read_b64_tr_b16 v[40:41], v6 offset:20480
    ds_read_b64_tr_b16 v[42:43], v6 offset:20992
    s_add_u32 s34, s5, s35
    v_cvt_pk_bf16_f32 v116, v116, v117
    v_mfma_f32_32x32x16_bf16 v[176:191], v[44:47], a[80:83], v[176:191]
    ds_read_b64_tr_b16 v[44:45], v7 offset:20480
    ds_read_b64_tr_b16 v[46:47], v7 offset:20992
    buffer_load_dwordx4 v25, s[44:47], s34 offen lds
    buffer_load_dwordx4 a[116:119], v2, s[40:43], s19 offen offset:1024 sc0 sc1
    buffer_load_dwordx4 a[120:123], v2, s[40:43], s19 offen offset:2048 sc0 sc1
    buffer_load_dwordx4 a[124:127], v2, s[40:43], s19 offen offset:3072 sc0 sc1
    s_waitcnt vmcnt(22)
    s_barrier
    s_waitcnt vmcnt(21)
    s_waitcnt lgkmcnt(12)
    v_mfma_f32_32x32x16_bf16 v[128:143], v[48:51], a[84:87], v[128:143]
    ds_read_b64_tr_b16 v[48:49], v4 offset:22528
    ds_read_b64_tr_b16 v[50:51], v4 offset:23040
    v_mfma_f32_32x32x16_bf16 v[144:159], v[52:55], a[84:87], v[144:159]
    ds_read_b64_tr_b16 v[52:53], v5 offset:22528
    ds_read_b64_tr_b16 v[54:55], v5 offset:23040
    v_bfe_i32 v117, v116, 0, 16
    s_add_u32 m0, s83, 0
    v_ashrrev_i32 v116, 16, v116
    s_waitcnt lgkmcnt(12)
    v_mfma_f32_32x32x16_bf16 v[160:175], v[56:59], a[84:87], v[160:175]
    ds_read_b64_tr_b16 v[56:57], v6 offset:22528
    ds_read_b64_tr_b16 v[58:59], v6 offset:23040
    s_add_u32 s34, s6, s35
    v_add_u32 v118, 16, v114
    v_mfma_f32_32x32x16_bf16 v[176:191], v[60:63], a[84:87], v[176:191]
    ds_read_b64_tr_b16 v[60:61], v7 offset:22528
    ds_read_b64_tr_b16 v[62:63], v7 offset:23040
    v_add_u32 v119, 17, v114
    buffer_load_dwordx4 v23, s[44:47], s34 offen lds
    s_waitcnt vmcnt(21)
    s_waitcnt lgkmcnt(12)
    v_mfma_f32_32x32x16_bf16 v[128:143], v[32:35], a[88:91], v[128:143]
    ds_read_b64_tr_b16 v[32:33], v4 offset:32768
    ds_read_b64_tr_b16 v[34:35], v4 offset:33280
    v_med3_i32 v117, v118, v117, v122
    v_mfma_f32_32x32x16_bf16 v[144:159], v[36:39], a[88:91], v[144:159]
    ds_read_b64_tr_b16 v[36:37], v5 offset:32768
    ds_read_b64_tr_b16 v[38:39], v5 offset:33280
    s_add_u32 m0, s83, 1024
    v_med3_i32 v116, v119, v116, v122
    s_add_u32 s34, s6, s35
    s_waitcnt lgkmcnt(12)
    v_mfma_f32_32x32x16_bf16 v[160:175], v[40:43], a[88:91], v[160:175]
    ds_read_b64_tr_b16 v[40:41], v6 offset:32768
    ds_read_b64_tr_b16 v[42:43], v6 offset:33280
    v_lshl_add_u32 v104, v117, 1, s48
    v_lshl_add_u32 v105, v116, 1, s48
    v_mfma_f32_32x32x16_bf16 v[176:191], v[44:47], a[88:91], v[176:191]
    ds_read_b64_tr_b16 v[44:45], v7 offset:32768
    ds_read_b64_tr_b16 v[46:47], v7 offset:33280
    buffer_load_dwordx4 v24, s[44:47], s34 offen lds
    v_add_f32 v116, 0x41900000, v115
    s_waitcnt vmcnt(21)
    s_waitcnt lgkmcnt(12)
    v_mfma_f32_32x32x16_bf16 v[128:143], v[48:51], a[92:95], v[128:143]
    ds_read_b64_tr_b16 v[48:49], v4 offset:34816
    ds_read_b64_tr_b16 v[50:51], v4 offset:35328
    s_add_u32 m0, s83, 2048
    v_mfma_f32_32x32x16_bf16 v[144:159], v[52:55], a[92:95], v[144:159]
    ds_read_b64_tr_b16 v[52:53], v5 offset:34816
    ds_read_b64_tr_b16 v[54:55], v5 offset:35328
    s_add_u32 s34, s6, s35
    v_add_f32 v117, 0x41980000, v115
    v_cvt_pk_bf16_f32 v116, v116, v117
    s_waitcnt lgkmcnt(12)
    v_mfma_f32_32x32x16_bf16 v[160:175], v[56:59], a[92:95], v[160:175]
    ds_read_b64_tr_b16 v[56:57], v6 offset:34816
    ds_read_b64_tr_b16 v[58:59], v6 offset:35328
    v_bfe_i32 v117, v116, 0, 16
    v_ashrrev_i32 v116, 16, v116
    v_mfma_f32_32x32x16_bf16 v[176:191], v[60:63], a[92:95], v[176:191]
    ds_read_b64_tr_b16 v[60:61], v7 offset:34816
    ds_read_b64_tr_b16 v[62:63], v7 offset:35328
    buffer_load_dwordx4 v25, s[44:47], s34 offen lds
    s_add_u32 m0, s83, 16384
    s_waitcnt vmcnt(21)
    s_waitcnt lgkmcnt(12)
    v_mfma_f32_32x32x16_bf16 v[128:143], v[32:35], a[96:99], v[128:143]
    ds_read_b64_tr_b16 v[32:33], v4 offset:36864
    ds_read_b64_tr_b16 v[34:35], v4 offset:37376
    s_add_u32 s34, s7, s35
    v_mfma_f32_32x32x16_bf16 v[144:159], v[36:39], a[96:99], v[144:159]
    ds_read_b64_tr_b16 v[36:37], v5 offset:36864
    ds_read_b64_tr_b16 v[38:39], v5 offset:37376
    v_add_u32 v118, 18, v114
    v_add_u32 v119, 19, v114
    v_med3_i32 v117, v118, v117, v122
    s_waitcnt lgkmcnt(12)
    v_mfma_f32_32x32x16_bf16 v[160:175], v[40:43], a[96:99], v[160:175]
    ds_read_b64_tr_b16 v[40:41], v6 offset:36864
    ds_read_b64_tr_b16 v[42:43], v6 offset:37376
    v_med3_i32 v116, v119, v116, v122
    v_mfma_f32_32x32x16_bf16 v[176:191], v[44:47], a[96:99], v[176:191]
    ds_read_b64_tr_b16 v[44:45], v7 offset:36864
    ds_read_b64_tr_b16 v[46:47], v7 offset:37376
    buffer_load_dwordx4 v23, s[44:47], s34 offen lds
    s_add_u32 m0, s83, 17408
    s_waitcnt vmcnt(18)
    s_barrier
    s_waitcnt vmcnt(17)
    s_waitcnt lgkmcnt(12)
    v_mfma_f32_32x32x16_bf16 v[128:143], v[48:51], a[100:103], v[128:143]
    ds_read_b64_tr_b16 v[48:49], v4 offset:38912
    ds_read_b64_tr_b16 v[50:51], v4 offset:39424
    v_mfma_f32_32x32x16_bf16 v[144:159], v[52:55], a[100:103], v[144:159]
    ds_read_b64_tr_b16 v[52:53], v5 offset:38912
    ds_read_b64_tr_b16 v[54:55], v5 offset:39424
    s_add_u32 s34, s7, s35
    v_lshl_add_u32 v106, v117, 1, s48
    v_lshl_add_u32 v107, v116, 1, s48
    s_waitcnt lgkmcnt(12)
    v_mfma_f32_32x32x16_bf16 v[160:175], v[56:59], a[100:103], v[160:175]
    ds_read_b64_tr_b16 v[56:57], v6 offset:38912
    ds_read_b64_tr_b16 v[58:59], v6 offset:39424
    v_add_f32 v116, 0x41a00000, v115
    v_add_f32 v117, 0x41a80000, v115
    v_mfma_f32_32x32x16_bf16 v[176:191], v[60:63], a[100:103], v[176:191]
    ds_read_b64_tr_b16 v[60:61], v7 offset:38912
    ds_read_b64_tr_b16 v[62:63], v7 offset:39424
    buffer_load_dwordx4 v24, s[44:47], s34 offen lds
    s_add_u32 m0, s83, 18432
    s_waitcnt vmcnt(17)
    s_waitcnt lgkmcnt(12)
    v_mfma_f32_32x32x16_bf16 v[128:143], v[32:35], a[104:107], v[128:143]
    ds_read_b64_tr_b16 v[32:33], v4 offset:49152
    ds_read_b64_tr_b16 v[34:35], v4 offset:49664
    s_add_u32 s34, s7, s35
    v_mfma_f32_32x32x16_bf16 v[144:159], v[36:39], a[104:107], v[144:159]
    ds_read_b64_tr_b16 v[36:37], v5 offset:49152
    ds_read_b64_tr_b16 v[38:39], v5 offset:49664
    v_cvt_pk_bf16_f32 v116, v116, v117
    v_bfe_i32 v117, v116, 0, 16
    v_ashrrev_i32 v116, 16, v116
    s_waitcnt lgkmcnt(12)
    v_mfma_f32_32x32x16_bf16 v[160:175], v[40:43], a[104:107], v[160:175]
    ds_read_b64_tr_b16 v[40:41], v6 offset:49152
    ds_read_b64_tr_b16 v[42:43], v6 offset:49664
    v_add_u32 v118, 20, v114
    v_mfma_f32_32x32x16_bf16 v[176:191], v[44:47], a[104:107], v[176:191]
    ds_read_b64_tr_b16 v[44:45], v7 offset:49152
    ds_read_b64_tr_b16 v[46:47], v7 offset:49664
    buffer_load_dwordx4 v25, s[44:47], s34 offen lds
    s_add_u32 m0, s83, 32768
    s_waitcnt vmcnt(17)
    s_waitcnt lgkmcnt(12)
    v_mfma_f32_32x32x16_bf16 v[128:143], v[48:51], a[108:111], v[128:143]
    ds_read_b64_tr_b16 v[48:49], v4 offset:51200
    ds_read_b64_tr_b16 v[50:51], v4 offset:51712
    s_add_u32 s34, s8, s35
    v_mfma_f32_32x32x16_bf16 v[144:159], v[52:55], a[108:111], v[144:159]
    ds_read_b64_tr_b16 v[52:53], v5 offset:51200
    ds_read_b64_tr_b16 v[54:55], v5 offset:51712
    v_add_u32 v119, 21, v114
    v_med3_i32 v117, v118, v117, v122
    v_med3_i32 v116, v119, v116, v122
    s_waitcnt lgkmcnt(12)
    v_mfma_f32_32x32x16_bf16 v[160:175], v[56:59], a[108:111], v[160:175]
    ds_read_b64_tr_b16 v[56:57], v6 offset:51200
    ds_read_b64_tr_b16 v[58:59], v6 offset:51712
    v_lshl_add_u32 v108, v117, 1, s48
    v_mfma_f32_32x32x16_bf16 v[176:191], v[60:63], a[108:111], v[176:191]
    ds_read_b64_tr_b16 v[60:61], v7 offset:51200
    ds_read_b64_tr_b16 v[62:63], v7 offset:51712
    buffer_load_dwordx4 v23, s[44:47], s34 offen lds
    s_add_u32 m0, s83, 33792
    s_waitcnt vmcnt(17)
    s_waitcnt lgkmcnt(12)
    v_mfma_f32_32x32x16_bf16 v[128:143], v[32:35], a[112:115], v[128:143]
    ds_read_b64_tr_b16 v[32:33], v4 offset:53248
    ds_read_b64_tr_b16 v[34:35], v4 offset:53760
    s_add_u32 s34, s8, s35
    v_mfma_f32_32x32x16_bf16 v[144:159], v[36:39], a[112:115], v[144:159]
    ds_read_b64_tr_b16 v[36:37], v5 offset:53248
    ds_read_b64_tr_b16 v[38:39], v5 offset:53760
    v_lshl_add_u32 v109, v116, 1, s48
    v_add_f32 v116, 0x41b00000, v115
    v_add_f32 v117, 0x41b80000, v115
    s_waitcnt lgkmcnt(12)
    v_mfma_f32_32x32x16_bf16 v[160:175], v[40:43], a[112:115], v[160:175]
    ds_read_b64_tr_b16 v[40:41], v6 offset:53248
    ds_read_b64_tr_b16 v[42:43], v6 offset:53760
    v_cvt_pk_bf16_f32 v116, v116, v117
    v_mfma_f32_32x32x16_bf16 v[176:191], v[44:47], a[112:115], v[176:191]
    ds_read_b64_tr_b16 v[44:45], v7 offset:53248
    ds_read_b64_tr_b16 v[46:47], v7 offset:53760
    buffer_load_dwordx4 v24, s[44:47], s34 offen lds
    s_add_u32 m0, s83, 34816
    s_waitcnt vmcnt(14)
    s_waitcnt vmcnt(11)
    s_barrier
    s_waitcnt vmcnt(10)
    s_waitcnt lgkmcnt(12)
    v_mfma_f32_32x32x16_bf16 v[128:143], v[48:51], a[116:119], v[128:143]
    ds_read_b64_tr_b16 v[48:49], v4 offset:55296
    ds_read_b64_tr_b16 v[50:51], v4 offset:55808
    v_mfma_f32_32x32x16_bf16 v[144:159], v[52:55], a[116:119], v[144:159]
    ds_read_b64_tr_b16 v[52:53], v5 offset:55296
    ds_read_b64_tr_b16 v[54:55], v5 offset:55808
    s_add_u32 s34, s8, s35
    v_bfe_i32 v117, v116, 0, 16
    v_ashrrev_i32 v116, 16, v116
    s_waitcnt lgkmcnt(12)
    v_mfma_f32_32x32x16_bf16 v[160:175], v[56:59], a[116:119], v[160:175]
    ds_read_b64_tr_b16 v[56:57], v6 offset:55296
    ds_read_b64_tr_b16 v[58:59], v6 offset:55808
    v_add_u32 v118, 22, v114
    v_add_u32 v119, 23, v114
    v_mfma_f32_32x32x16_bf16 v[176:191], v[60:63], a[116:119], v[176:191]
    ds_read_b64_tr_b16 v[60:61], v7 offset:55296
    ds_read_b64_tr_b16 v[62:63], v7 offset:55808
    buffer_load_dwordx4 v25, s[44:47], s34 offen lds
    s_add_u32 m0, s83, 49152
    s_waitcnt vmcnt(10)
    s_waitcnt lgkmcnt(12)
    v_mfma_f32_32x32x16_bf16 v[128:143], v[32:35], a[120:123], v[128:143]
    ds_read_b64_tr_b16 v[32:33], v27 offset:0
    ds_read_b64_tr_b16 v[34:35], v27 offset:384
    s_add_u32 s34, s9, s35
    v_mfma_f32_32x32x16_bf16 v[144:159], v[36:39], a[120:123], v[144:159]
    ds_read_b64_tr_b16 v[36:37], v27 offset:32
    ds_read_b64_tr_b16 v[38:39], v27 offset:416
    v_med3_i32 v117, v118, v117, v122
    v_med3_i32 v116, v119, v116, v122
    v_lshl_add_u32 v110, v117, 1, s48
    s_waitcnt lgkmcnt(12)
    v_mfma_f32_32x32x16_bf16 v[160:175], v[40:43], a[120:123], v[160:175]
    ds_read_b64_tr_b16 v[40:41], v27 offset:64
    ds_read_b64_tr_b16 v[42:43], v27 offset:448
    v_lshl_add_u32 v111, v116, 1, s48
    v_mfma_f32_32x32x16_bf16 v[176:191], v[44:47], a[120:123], v[176:191]
    ds_read_b64_tr_b16 v[44:45], v27 offset:1536
    ds_read_b64_tr_b16 v[46:47], v27 offset:1920
    buffer_load_dwordx4 v23, s[44:47], s34 offen lds
    s_add_u32 m0, s83, 50176
    s_waitcnt vmcnt(10)
    s_waitcnt lgkmcnt(12)
    v_mfma_f32_32x32x16_bf16 v[128:143], v[48:51], a[124:127], v[128:143]
    ds_read_b64_tr_b16 v[48:49], v27 offset:1568
    ds_read_b64_tr_b16 v[50:51], v27 offset:1952
    s_add_u32 s34, s9, s35
    v_mfma_f32_32x32x16_bf16 v[144:159], v[52:55], a[124:127], v[144:159]
    ds_read_b64_tr_b16 v[52:53], v27 offset:1600
    ds_read_b64_tr_b16 v[54:55], v27 offset:1984
    buffer_load_dwordx4 v24, s[44:47], s34 offen lds
    s_add_u32 m0, s83, 51200
    s_add_u32 s34, s9, s35
    buffer_load_dwordx4 v25, s[44:47], s34 offen lds
    s_waitcnt lgkmcnt(12)
    v_mfma_f32_32x32x16_bf16 v[160:175], v[56:59], a[124:127], v[160:175]
    ds_read_b64_tr_b16 v[56:57], v27 offset:3072
    ds_read_b64_tr_b16 v[58:59], v27 offset:3456
    v_mfma_f32_32x32x16_bf16 v[176:191], v[60:63], a[124:127], v[176:191]
    ds_read_b64_tr_b16 v[60:61], v27 offset:3104
    ds_read_b64_tr_b16 v[62:63], v27 offset:3488
    s_nop 5
    v_pk_mul_f32 v[64:65], v[128:129], v[128:129]
    v_pk_mul_f32 v[66:67], v[130:131], v[130:131]
    v_pk_mul_f32 v[68:69], v[132:133], v[132:133]
    s_nop 0
    v_pk_mul_f32 v[70:71], v[134:135], v[134:135]
    v_pk_fma_f32 v[64:65], v[64:65], s[86:87], v[120:121]
    v_lshrrev_b32_e64 v244, 2, v1
    v_pk_fma_f32 v[66:67], v[66:67], s[86:87], v[120:121]
    v_lshlrev_b32_e64 v244, 8, v244
    v_pk_fma_f32 v[68:69], v[68:69], s[86:87], v[120:121]
    v_and_b32_e64 v240, 3, v1
    v_pk_fma_f32 v[70:71], v[70:71], s[86:87], v[120:121]
    v_pk_mul_f32 v[64:65], v[64:65], v[128:129]
    v_lshl_add_u32 v244, v240, 4, v244
    v_pk_mul_f32 v[66:67], v[66:67], v[130:131]
    v_add_u32 v244, 16384, v244
    v_pk_mul_f32 v[68:69], v[68:69], v[132:133]
    buffer_load_dwordx4 v[240:243], v244, s[40:43], 0 offen sc0 sc1
    v_pk_mul_f32 v[70:71], v[70:71], v[134:135]
    v_exp_f32 v64, v64
    v_exp_f32 v65, v65
    v_exp_f32 v66, v66
    v_exp_f32 v67, v67
    v_exp_f32 v68, v68
    v_exp_f32 v69, v69
    v_exp_f32 v70, v70
    v_exp_f32 v71, v71
    v_pk_mul_f32 v[128:129], v[128:129], v[136:137]
    v_pk_mul_f32 v[130:131], v[130:131], v[138:139]
    v_pk_mul_f32 v[132:133], v[132:133], v[140:141]
    v_pk_mul_f32 v[134:135], v[134:135], v[142:143]
    v_pk_add_f32 v[64:65], v[64:65], 1.0 op_sel_hi:[1,0]
    v_pk_add_f32 v[66:67], v[66:67], 1.0 op_sel_hi:[1,0]
    v_pk_add_f32 v[68:69], v[68:69], 1.0 op_sel_hi:[1,0]
    v_pk_add_f32 v[70:71], v[70:71], 1.0 op_sel_hi:[1,0]
    v_rcp_f32 v64, v64
    v_rcp_f32 v65, v65
    v_rcp_f32 v66, v66
    v_rcp_f32 v67, v67
    v_rcp_f32 v68, v68
    v_rcp_f32 v69, v69
    v_rcp_f32 v70, v70
    v_rcp_f32 v71, v71
    v_pk_mul_f32 v[128:129], v[128:129], v[64:65]
    v_pk_mul_f32 v[130:131], v[130:131], v[66:67]
    v_pk_mul_f32 v[132:133], v[132:133], v[68:69]
    v_pk_mul_f32 v[134:135], v[134:135], v[70:71]
    v_cvt_pk_bf16_f32 v80, v128, v129
    v_cvt_pk_bf16_f32 v81, v130, v131
    v_cvt_pk_bf16_f32 v82, v132, v133
    v_cvt_pk_bf16_f32 v83, v134, v135
    buffer_store_dwordx4 v[80:83], v2, s[40:43], s98 offen offset:0 sc0 sc1
    v_pk_mul_f32 v[72:73], v[144:145], v[144:145]
    v_pk_mul_f32 v[74:75], v[146:147], v[146:147]
    v_pk_mul_f32 v[76:77], v[148:149], v[148:149]
    v_pk_mul_f32 v[78:79], v[150:151], v[150:151]
    v_pk_fma_f32 v[72:73], v[72:73], s[86:87], v[120:121]
    v_pk_fma_f32 v[74:75], v[74:75], s[86:87], v[120:121]
    v_pk_fma_f32 v[76:77], v[76:77], s[86:87], v[120:121]
    v_pk_fma_f32 v[78:79], v[78:79], s[86:87], v[120:121]
    v_pk_mul_f32 v[72:73], v[72:73], v[144:145]
    v_pk_mul_f32 v[74:75], v[74:75], v[146:147]
    v_pk_mul_f32 v[76:77], v[76:77], v[148:149]
    v_pk_mul_f32 v[78:79], v[78:79], v[150:151]
    v_exp_f32 v72, v72
    v_exp_f32 v73, v73
    v_exp_f32 v74, v74
    v_exp_f32 v75, v75
    v_exp_f32 v76, v76
    v_exp_f32 v77, v77
    v_exp_f32 v78, v78
    v_exp_f32 v79, v79
    v_pk_mul_f32 v[144:145], v[144:145], v[152:153]
    v_pk_mul_f32 v[146:147], v[146:147], v[154:155]
    v_pk_mul_f32 v[148:149], v[148:149], v[156:157]
    v_pk_mul_f32 v[150:151], v[150:151], v[158:159]
    v_pk_add_f32 v[72:73], v[72:73], 1.0 op_sel_hi:[1,0]
    v_pk_add_f32 v[74:75], v[74:75], 1.0 op_sel_hi:[1,0]
    v_pk_add_f32 v[76:77], v[76:77], 1.0 op_sel_hi:[1,0]
    v_pk_add_f32 v[78:79], v[78:79], 1.0 op_sel_hi:[1,0]
    v_rcp_f32 v72, v72
    v_rcp_f32 v73, v73
    v_rcp_f32 v74, v74
    v_rcp_f32 v75, v75
    v_rcp_f32 v76, v76
    v_rcp_f32 v77, v77
    v_rcp_f32 v78, v78
    v_rcp_f32 v79, v79
    v_pk_mul_f32 v[144:145], v[144:145], v[72:73]
    v_pk_mul_f32 v[146:147], v[146:147], v[74:75]
    v_pk_mul_f32 v[148:149], v[148:149], v[76:77]
    v_pk_mul_f32 v[150:151], v[150:151], v[78:79]
    v_cvt_pk_bf16_f32 v84, v144, v145
    v_cvt_pk_bf16_f32 v85, v146, v147
    v_cvt_pk_bf16_f32 v86, v148, v149
    v_cvt_pk_bf16_f32 v87, v150, v151
    buffer_store_dwordx4 v[84:87], v2, s[40:43], s98 offen offset:1024 sc0 sc1
    v_pk_mul_f32 v[64:65], v[160:161], v[160:161]
    v_pk_mul_f32 v[66:67], v[162:163], v[162:163]
    v_pk_mul_f32 v[68:69], v[164:165], v[164:165]
    v_pk_mul_f32 v[70:71], v[166:167], v[166:167]
    v_pk_fma_f32 v[64:65], v[64:65], s[86:87], v[120:121]
    v_pk_fma_f32 v[66:67], v[66:67], s[86:87], v[120:121]
    v_pk_fma_f32 v[68:69], v[68:69], s[86:87], v[120:121]
    v_pk_fma_f32 v[70:71], v[70:71], s[86:87], v[120:121]
    v_pk_mul_f32 v[64:65], v[64:65], v[160:161]
    v_pk_mul_f32 v[66:67], v[66:67], v[162:163]
    v_pk_mul_f32 v[68:69], v[68:69], v[164:165]
    v_pk_mul_f32 v[70:71], v[70:71], v[166:167]
    v_exp_f32 v64, v64
    v_exp_f32 v65, v65
    v_exp_f32 v66, v66
    v_exp_f32 v67, v67
    v_exp_f32 v68, v68
    v_exp_f32 v69, v69
    v_exp_f32 v70, v70
    v_exp_f32 v71, v71
    v_pk_mul_f32 v[160:161], v[160:161], v[168:169]
    v_pk_mul_f32 v[162:163], v[162:163], v[170:171]
    v_pk_mul_f32 v[164:165], v[164:165], v[172:173]
    v_pk_mul_f32 v[166:167], v[166:167], v[174:175]
    v_pk_add_f32 v[64:65], v[64:65], 1.0 op_sel_hi:[1,0]
    v_pk_add_f32 v[66:67], v[66:67], 1.0 op_sel_hi:[1,0]
    v_pk_add_f32 v[68:69], v[68:69], 1.0 op_sel_hi:[1,0]
    v_pk_add_f32 v[70:71], v[70:71], 1.0 op_sel_hi:[1,0]
    v_rcp_f32 v64, v64
    v_rcp_f32 v65, v65
    v_rcp_f32 v66, v66
    v_rcp_f32 v67, v67
    v_rcp_f32 v68, v68
    v_rcp_f32 v69, v69
    v_rcp_f32 v70, v70
    v_rcp_f32 v71, v71
    v_pk_mul_f32 v[160:161], v[160:161], v[64:65]
    v_pk_mul_f32 v[162:163], v[162:163], v[66:67]
    v_pk_mul_f32 v[164:165], v[164:165], v[68:69]
    v_pk_mul_f32 v[166:167], v[166:167], v[70:71]
    v_cvt_pk_bf16_f32 v80, v160, v161
    v_cvt_pk_bf16_f32 v81, v162, v163
    v_cvt_pk_bf16_f32 v82, v164, v165
    v_cvt_pk_bf16_f32 v83, v166, v167
    buffer_store_dwordx4 v[80:83], v2, s[40:43], s98 offen offset:2048 sc0 sc1
    v_pk_mul_f32 v[72:73], v[176:177], v[176:177]
    v_pk_mul_f32 v[74:75], v[178:179], v[178:179]
    v_pk_mul_f32 v[76:77], v[180:181], v[180:181]
    v_pk_mul_f32 v[78:79], v[182:183], v[182:183]
    v_pk_fma_f32 v[72:73], v[72:73], s[86:87], v[120:121]
    v_pk_fma_f32 v[74:75], v[74:75], s[86:87], v[120:121]
    v_pk_fma_f32 v[76:77], v[76:77], s[86:87], v[120:121]
    v_pk_fma_f32 v[78:79], v[78:79], s[86:87], v[120:121]
    v_pk_mul_f32 v[72:73], v[72:73], v[176:177]
    v_pk_mul_f32 v[74:75], v[74:75], v[178:179]
    v_pk_mul_f32 v[76:77], v[76:77], v[180:181]
    v_pk_mul_f32 v[78:79], v[78:79], v[182:183]
    v_exp_f32 v72, v72
    v_exp_f32 v73, v73
    v_exp_f32 v74, v74
    v_exp_f32 v75, v75
    v_exp_f32 v76, v76
    v_exp_f32 v77, v77
    v_exp_f32 v78, v78
    v_exp_f32 v79, v79
    v_pk_mul_f32 v[176:177], v[176:177], v[184:185]
    v_pk_mul_f32 v[178:179], v[178:179], v[186:187]
    v_pk_mul_f32 v[180:181], v[180:181], v[188:189]
    v_pk_mul_f32 v[182:183], v[182:183], v[190:191]
    v_pk_add_f32 v[72:73], v[72:73], 1.0 op_sel_hi:[1,0]
    v_pk_add_f32 v[74:75], v[74:75], 1.0 op_sel_hi:[1,0]
    v_pk_add_f32 v[76:77], v[76:77], 1.0 op_sel_hi:[1,0]
    v_pk_add_f32 v[78:79], v[78:79], 1.0 op_sel_hi:[1,0]
    v_rcp_f32 v72, v72
    v_rcp_f32 v73, v73
    v_rcp_f32 v74, v74
    v_rcp_f32 v75, v75
    v_rcp_f32 v76, v76
    v_rcp_f32 v77, v77
    v_rcp_f32 v78, v78
    v_rcp_f32 v79, v79
    v_pk_mul_f32 v[176:177], v[176:177], v[72:73]
    v_pk_mul_f32 v[178:179], v[178:179], v[74:75]
    v_pk_mul_f32 v[180:181], v[180:181], v[76:77]
    v_pk_mul_f32 v[182:183], v[182:183], v[78:79]
    v_cvt_pk_bf16_f32 v84, v176, v177
    v_cvt_pk_bf16_f32 v85, v178, v179
    v_cvt_pk_bf16_f32 v86, v180, v181
    v_cvt_pk_bf16_f32 v87, v182, v183
    buffer_store_dwordx4 v[84:87], v2, s[40:43], s98 offen offset:3072 sc0 sc1
    s_waitcnt vmcnt(4)
    v_xor_b32 v240, s68, v240
    v_xor_b32 v241, s68, v241
    v_xor_b32 v242, s68, v242
    v_xor_b32 v243, s68, v243
    v_or_b32 v240, v240, v241
    v_or3_b32 v240, v240, v242, v243
    v_cmp_ne_u32 vcc, 0, v240
    s_nop 4
    s_cmp_eq_u64 vcc, 0
    s_cbranch_scc0 L_slow_c1
L_ok_c1:
    s_waitcnt lgkmcnt(12)
    v_mfma_f32_32x32x16_bf16 v[192:207], v[32:35], a[0:3], 0
    ds_read_b64_tr_b16 v[32:33], v27 offset:3136
    ds_read_b64_tr_b16 v[34:35], v27 offset:3520
    buffer_load_dwordx4 a[128:131], v2, s[40:43], s27 offen offset:0 sc0 sc1
    v_mfma_f32_32x32x16_bf16 v[208:223], v[36:39], a[0:3], 0
    ds_read_b64_tr_b16 v[36:37], v27 offset:4608
    ds_read_b64_tr_b16 v[38:39], v27 offset:4992
    s_waitcnt lgkmcnt(12)
    v_mfma_f32_32x32x16_bf16 v[224:239], v[40:43], a[0:3], 0
    ds_read_b64_tr_b16 v[40:41], v27 offset:4640
    ds_read_b64_tr_b16 v[42:43], v27 offset:5024
    ds_read_u16 v93, v93
    ds_read_u16 v94, v94
    v_mfma_f32_32x32x16_bf16 v[192:207], v[44:47], a[4:7], v[192:207]
    ds_read_b64_tr_b16 v[44:45], v27 offset:4672
    ds_read_b64_tr_b16 v[46:47], v27 offset:5056
    ds_read_u16 v95, v95
    s_waitcnt lgkmcnt(15)
    v_mfma_f32_32x32x16_bf16 v[208:223], v[48:51], a[4:7], v[208:223]
    ds_read_b64_tr_b16 v[48:49], v27 offset:12416
    ds_read_b64_tr_b16 v[50:51], v27 offset:12800
    ds_read_u16 v96, v96
    v_mfma_f32_32x32x16_bf16 v[224:239], v[52:55], a[4:7], v[224:239]
    ds_read_b64_tr_b16 v[52:53], v27 offset:12448
    ds_read_b64_tr_b16 v[54:55], v27 offset:12832
    ds_read_u16 v97, v97
    s_waitcnt lgkmcnt(15)
    v_mfma_f32_32x32x16_bf16 v[192:207], v[56:59], a[8:11], v[192:207]
    ds_read_b64_tr_b16 v[56:57], v27 offset:12480
    ds_read_b64_tr_b16 v[58:59], v27 offset:12864
    buffer_load_dwordx4 a[132:135], v2, s[40:43], s27 offen offset:1024 sc0 sc1
    v_mfma_f32_32x32x16_bf16 v[208:223], v[60:63], a[8:11], v[208:223]
    ds_read_b64_tr_b16 v[60:61], v27 offset:13952
    ds_read_b64_tr_b16 v[62:63], v27 offset:14336
    ds_read_u16 v98, v98
    ds_read_u16 v99, v99
    ds_read_u16 v100, v100
    s_waitcnt lgkmcnt(15)
    v_mfma_f32_32x32x16_bf16 v[224:239], v[32:35], a[8:11], v[224:239]
    ds_read_b64_tr_b16 v[32:33], v27 offset:13984
    ds_read_b64_tr_b16 v[34:35], v27 offset:14368
    ds_read_u16 v101, v101
    v_mfma_f32_32x32x16_bf16 v[192:207], v[36:39], a[12:15], v[192:207]
    ds_read_b64_tr_b16 v[36:37], v27 offset:14016
    ds_read_b64_tr_b16 v[38:39], v27 offset:14400
    ds_read_u16 v102, v102
    s_waitcnt lgkmcnt(15)
    v_mfma_f32_32x32x16_bf16 v[208:223], v[40:43], a[12:15], v[208:223]
    ds_read_b64_tr_b16 v[40:41], v27 offset:15488
    ds_read_b64_tr_b16 v[42:43], v27 offset:15872
    ds_read_u16 v103, v103
    v_mfma_f32_32x32x16_bf16 v[224:239], v[44:47], a[12:15], v[224:239]
    ds_read_b64_tr_b16 v[44:45], v27 offset:15520
    ds_read_b64_tr_b16 v[46:47], v27 offset:15904
    ds_read_u16 v104, v104
    ds_read_u16 v105, v105
    s_waitcnt vmcnt(2)
    s_barrier
    s_add_u32 s99, s92, s69
    v_mov_b32 v254, s99
    v_mov_b32 v255, s68
    s_mov_b64 exec, 1
    buffer_store_dword v255, v254, s[40:43], 0 offen sc0 sc1
    s_mov_b64 exec, -1
    s_waitcnt lgkmcnt(15)
    v_mfma_f32_32x32x16_bf16 v[192:207], v[48:51], a[16:19], v[192:207]
    ds_read_b64_tr_b16 v[48:49], v27 offset:15552
    ds_read_b64_tr_b16 v[50:51], v27 offset:15936
    v_mfma_f32_32x32x16_bf16 v[208:223], v[52:55], a[16:19], v[208:223]
    ds_read_b64_tr_b16 v[52:53], v27 offset:17024
    ds_read_b64_tr_b16 v[54:55], v27 offset:17408
    s_add_u32 m0, s83, 65536
    ds_read_u16 v106, v106
    ds_read_u16 v107, v107
    v_mfma_f32_32x32x16_bf16 v[224:239], v[56:59], a[16:19], v[224:239]
    ds_read_b64_tr_b16 v[56:57], v27 offset:17056
    ds_read_b64_tr_b16 v[58:59], v27 offset:17440
    s_add_u32 s34, s10, s35
    ds_read_u16 v108, v108
    v_mfma_f32_32x32x16_bf16 v[192:207], v[60:63], a[20:23], v[192:207]
    ds_read_b64_tr_b16 v[60:61], v27 offset:17088
    ds_read_b64_tr_b16 v[62:63], v27 offset:17472
    buffer_load_dwordx4 v23, s[44:47], s34 offen lds
    s_add_u32 m0, s83, 66560
    s_waitcnt lgkmcnt(15)
    v_mfma_f32_32x32x16_bf16 v[208:223], v[32:35], a[20:23], v[208:223]
    ds_read_b64_tr_b16 v[32:33], v28 offset:0
    ds_read_b64_tr_b16 v[34:35], v28 offset:384
    ds_read_u16 v109, v109
    s_add_u32 s34, s10, s35
    v_mfma_f32_32x32x16_bf16 v[224:239], v[36:39], a[20:23], v[224:239]
    ds_read_b64_tr_b16 v[36:37], v28 offset:32
    ds_read_b64_tr_b16 v[38:39], v28 offset:416
    ds_read_u16 v110, v110
    ds_read_u16 v111, v111
    s_waitcnt lgkmcnt(0)
    v_mfma_f32_32x32x16_bf16 v[192:207], v[40:43], a[24:27], v[192:207]
    ds_read_b64_tr_b16 v[40:41], v28 offset:64
    ds_read_b64_tr_b16 v[42:43], v28 offset:448
    v_lshl_or_b32 v128, v95, 16, v96
    v_mfma_f32_32x32x16_bf16 v[208:223], v[44:47], a[24:27], v[208:223]
    ds_read_b64_tr_b16 v[44:45], v28 offset:1536
    ds_read_b64_tr_b16 v[46:47], v28 offset:1920
    buffer_load_dwordx4 v24, s[44:47], s34 offen lds
    s_add_u32 m0, s83, 67584
    v_mfma_f32_32x32x16_bf16 v[224:239], v[48:51], a[24:27], v[224:239]
    ds_read_b64_tr_b16 v[48:49], v28 offset:1568
    ds_read_b64_tr_b16 v[50:51], v28 offset:1952
    s_add_u32 s34, s10, s35
    v_lshl_or_b32 v129, v93, 16, v94
    v_mfma_f32_32x32x16_bf16 v[192:207], v[52:55], a[28:31], v[192:207]
    ds_read_b64_tr_b16 v[52:53], v28 offset:1600
    ds_read_b64_tr_b16 v[54:55], v28 offset:1984
    v_lshl_or_b32 v130, v99, 16, v100
    v_lshl_or_b32 v131, v97, 16, v98
    v_lshl_or_b32 v132, v103, 16, v104
    v_mfma_f32_32x32x16_bf16 v[208:223], v[56:59], a[28:31], v[208:223]
    ds_read_b64_tr_b16 v[56:57], v28 offset:3072
    ds_read_b64_tr_b16 v[58:59], v28 offset:3456
    v_lshl_or_b32 v133, v101, 16, v102
    v_mfma_f32_32x32x16_bf16 v[224:239], v[60:63], a[28:31], v[224:239]
    ds_read_b64_tr_b16 v[60:61], v28 offset:3104
    ds_read_b64_tr_b16 v[62:63], v28 offset:3488
    buffer_load_dwordx4 v25, s[44:47], s34 offen lds
    s_add_u32 m0, s83, 81920
    v_mfma_f32_32x32x16_bf16 v[192:207], v[32:35], a[32:35], v[192:207]
    ds_read_b64_tr_b16 v[32:33], v28 offset:3136
    ds_read_b64_tr_b16 v[34:35], v28 offset:3520
    s_add_u32 s34, s11, s35
    v_lshl_or_b32 v134, v107, 16, v108
    v_mfma_f32_32x32x16_bf16 v[208:223], v[36:39], a[32:35], v[208:223]
    ds_read_b64_tr_b16 v[36:37], v28 offset:4608
    ds_read_b64_tr_b16 v[38:39], v28 offset:4992
    v_lshl_or_b32 v135, v105, 16, v106
    v_lshl_or_b32 v136, v96, 16, v97
    s_waitcnt lgkmcnt(12)
    v_mfma_f32_32x32x16_bf16 v[224:239], v[40:43], a[32:35], v[224:239]
    ds_read_b64_tr_b16 v[40:41], v28 offset:4640
    ds_read_b64_tr_b16 v[42:43], v28 offset:5024
    v_lshl_or_b32 v137, v94, 16, v95
    v_lshl_or_b32 v138, v100, 16, v101
    v_mfma_f32_32x32x16_bf16 v[192:207], v[44:47], a[36:39], v[192:207]
    ds_read_b64_tr_b16 v[44:45], v28 offset:4672
    ds_read_b64_tr_b16 v[46:47], v28 offset:5056
    buffer_load_dwordx4 v23, s[44:47], s34 offen lds
    s_add_u32 m0, s83, 82944
    s_waitcnt lgkmcnt(12)
    v_mfma_f32_32x32x16_bf16 v[208:223], v[48:51], a[36:39], v[208:223]
    ds_read_b64_tr_b16 v[48:49], v28 offset:16384
    ds_read_b64_tr_b16 v[50:51], v28 offset:16768
    s_add_u32 s34, s11, s35
    v_lshl_or_b32 v139, v98, 16, v99
    v_mfma_f32_32x32x16_bf16 v[224:239], v[52:55], a[36:39], v[224:239]
    ds_read_b64_tr_b16 v[52:53], v28 offset:16416
    ds_read_b64_tr_b16 v[54:55], v28 offset:16800
    buffer_load_dwordx4 v24, s[44:47], s34 offen lds
    s_add_u32 m0, s83, 83968
    s_add_u32 s34, s11, s35
    buffer_load_dwordx4 v25, s[44:47], s34 offen lds
    s_waitcnt lgkmcnt(12)
    v_mfma_f32_32x32x16_bf16 v[192:207], v[56:59], a[40:43], v[192:207]
    ds_read_b64_tr_b16 v[56:57], v28 offset:16448
    ds_read_b64_tr_b16 v[58:59], v28 offset:16832
    v_lshl_or_b32 v140, v104, 16, v105
    v_lshl_or_b32 v141, v102, 16, v103
    v_mfma_f32_32x32x16_bf16 v[208:223], v[60:63], a[40:43], v[208:223]
    ds_read_b64_tr_b16 v[60:61], v28 offset:17920
    ds_read_b64_tr_b16 v[62:63], v28 offset:18304
    v_lshl_or_b32 v142, v108, 16, v109
    v_lshl_or_b32 v143, v106, 16, v107
    v_lshl_or_b32 v144, v97, 16, v98
    s_waitcnt lgkmcnt(12)
    v_mfma_f32_32x32x16_bf16 v[224:239], v[32:35], a[40:43], v[224:239]
    ds_read_b64_tr_b16 v[32:33], v28 offset:17952
    ds_read_b64_tr_b16 v[34:35], v28 offset:18336
    v_lshl_or_b32 v145, v95, 16, v96
    v_mfma_f32_32x32x16_bf16 v[192:207], v[36:39], a[44:47], v[192:207]
    ds_read_b64_tr_b16 v[36:37], v28 offset:17984
    ds_read_b64_tr_b16 v[38:39], v28 offset:18368
    buffer_load_dwordx4 a[136:139], v2, s[40:43], s27 offen offset:2048 sc0 sc1
    v_lshl_or_b32 v146, v101, 16, v102
    s_waitcnt lgkmcnt(12)
    v_mfma_f32_32x32x16_bf16 v[208:223], v[40:43], a[44:47], v[208:223]
    ds_read_b64_tr_b16 v[40:41], v28 offset:19456
    ds_read_b64_tr_b16 v[42:43], v28 offset:19840
    v_lshl_or_b32 v147, v99, 16, v100
    v_mfma_f32_32x32x16_bf16 v[224:239], v[44:47], a[44:47], v[224:239]
    ds_read_b64_tr_b16 v[44:45], v28 offset:19488
    ds_read_b64_tr_b16 v[46:47], v28 offset:19872
    buffer_load_dwordx4 a[140:143], v2, s[40:43], s27 offen offset:3072 sc0 sc1
    v_lshl_or_b32 v148, v105, 16, v106
    s_waitcnt lgkmcnt(12)
    v_mfma_f32_32x32x16_bf16 v[192:207], v[48:51], a[48:51], v[192:207]
    ds_read_b64_tr_b16 v[48:49], v28 offset:19520
    ds_read_b64_tr_b16 v[50:51], v28 offset:19904
    v_lshl_or_b32 v149, v103, 16, v104
    v_lshl_or_b32 v150, v109, 16, v110
    v_mfma_f32_32x32x16_bf16 v[208:223], v[52:55], a[48:51], v[208:223]
    ds_read_b64_tr_b16 v[52:53], v28 offset:20992
    ds_read_b64_tr_b16 v[54:55], v28 offset:21376
    v_lshl_or_b32 v151, v107, 16, v108
    s_waitcnt lgkmcnt(12)
    v_mfma_f32_32x32x16_bf16 v[224:239], v[56:59], a[48:51], v[224:239]
    ds_read_b64_tr_b16 v[56:57], v28 offset:21024
    ds_read_b64_tr_b16 v[58:59], v28 offset:21408
    buffer_load_dwordx4 a[144:147], v253, s[40:43], s27 offen offset:0 sc0 sc1
    v_mfma_f32_32x32x16_bf16 v[192:207], v[60:63], a[52:55], v[192:207]
    ds_read_b64_tr_b16 v[60:61], v28 offset:21056
    ds_read_b64_tr_b16 v[62:63], v28 offset:21440
    v_lshl_or_b32 v152, v98, 16, v99
    v_lshl_or_b32 v153, v96, 16, v97
    s_waitcnt lgkmcnt(12)
    v_mfma_f32_32x32x16_bf16 v[208:223], v[32:35], a[52:55], v[208:223]
    ds_read_b64_tr_b16 v[32:33], v28 offset:32768
    ds_read_b64_tr_b16 v[34:35], v28 offset:33152
    v_lshl_or_b32 v154, v102, 16, v103
    v_lshl_or_b32 v155, v100, 16, v101
    v_mfma_f32_32x32x16_bf16 v[224:239], v[36:39], a[52:55], v[224:239]
    ds_read_b64_tr_b16 v[36:37], v28 offset:32800
    ds_read_b64_tr_b16 v[38:39], v28 offset:33184
    buffer_load_dwordx4 a[148:151], v253, s[40:43], s27 offen offset:1024 sc0 sc1
    v_lshl_or_b32 v156, v106, 16, v107
    s_waitcnt lgkmcnt(12)
    v_mfma_f32_32x32x16_bf16 v[192:207], v[40:43], a[56:59], v[192:207]
    ds_read_b64_tr_b16 v[40:41], v28 offset:32832
    ds_read_b64_tr_b16 v[42:43], v28 offset:33216
    v_lshl_or_b32 v157, v104, 16, v105
    v_mfma_f32_32x32x16_bf16 v[208:223], v[44:47], a[56:59], v[208:223]
    ds_read_b64_tr_b16 v[44:45], v28 offset:34304
    ds_read_b64_tr_b16 v[46:47], v28 offset:34688
    v_lshl_or_b32 v158, v110, 16, v111
    s_waitcnt lgkmcnt(12)
    v_mfma_f32_32x32x16_bf16 v[224:239], v[48:51], a[56:59], v[224:239]
    ds_read_b64_tr_b16 v[48:49], v28 offset:34336
    ds_read_b64_tr_b16 v[50:51], v28 offset:34720
    v_lshl_or_b32 v159, v108, 16, v109
    v_mfma_f32_32x32x16_bf16 v[192:207], v[52:55], a[60:63], v[192:207]
    ds_read_b64_tr_b16 v[52:53], v28 offset:34368
    ds_read_b64_tr_b16 v[54:55], v28 offset:34752
    buffer_load_dwordx4 a[152:155], v253, s[40:43], s27 offen offset:2048 sc0 sc1
    s_lshl_b32 s48, s81, 6
    s_waitcnt lgkmcnt(12)
    v_mfma_f32_32x32x16_bf16 v[208:223], v[56:59], a[60:63], v[208:223]
    ds_read_b64_tr_b16 v[56:57], v28 offset:35840
    ds_read_b64_tr_b16 v[58:59], v28 offset:36224
    v_add_u32 v118, s48, v1
    s_mul_i32 s48, s82, 16640
    v_mfma_f32_32x32x16_bf16 v[224:239], v[60:63], a[60:63], v[224:239]
    ds_read_b64_tr_b16 v[60:61], v28 offset:35872
    ds_read_b64_tr_b16 v[62:63], v28 offset:36256
    s_add_u32 s48, s48, 94368
    s_waitcnt lgkmcnt(12)
    v_mfma_f32_32x32x16_bf16 v[192:207], v[32:35], a[64:67], v[192:207]
    ds_read_b64_tr_b16 v[32:33], v28 offset:35904
    ds_read_b64_tr_b16 v[34:35], v28 offset:36288
    buffer_load_dwordx4 a[156:159], v253, s[40:43], s27 offen offset:3072 sc0 sc1
    v_mfma_f32_32x32x16_bf16 v[208:223], v[36:39], a[64:67], v[208:223]
    ds_read_b64_tr_b16 v[36:37], v28 offset:37376
    ds_read_b64_tr_b16 v[38:39], v28 offset:37760
    v_lshl_add_u32 v112, v118, 5, s48
    v_lshrrev_b32 v118, 1, v1
    s_waitcnt lgkmcnt(12)
    v_mfma_f32_32x32x16_bf16 v[224:239], v[40:43], a[64:67], v[224:239]
    ds_read_b64_tr_b16 v[40:41], v28 offset:37408
    ds_read_b64_tr_b16 v[42:43], v28 offset:37792
    v_mul_u32_u24 v118, 4160, v118
    v_and_b32 v113, 1, v1
    v_mfma_f32_32x32x16_bf16 v[192:207], v[44:47], a[68:71], v[192:207]
    ds_read_b64_tr_b16 v[44:45], v28 offset:37440
    ds_read_b64_tr_b16 v[46:47], v28 offset:37824
    v_lshl_add_u32 v118, v113, 4, v118
    s_waitcnt lgkmcnt(12)
    v_mfma_f32_32x32x16_bf16 v[208:223], v[48:51], a[68:71], v[208:223]
    ds_read_b64_tr_b16 v[48:49], v28 offset:49152
    ds_read_b64_tr_b16 v[50:51], v28 offset:49536
    buffer_load_dwordx4 a[160:163], v2, s[40:43], s28 offen offset:0 sc0 sc1
    v_mfma_f32_32x32x16_bf16 v[224:239], v[52:55], a[68:71], v[224:239]
    ds_read_b64_tr_b16 v[52:53], v28 offset:49184
    ds_read_b64_tr_b16 v[54:55], v28 offset:49568
    s_sub_u32 s48, s48, 32
    v_add_u32 v113, s48, v118
    s_waitcnt lgkmcnt(12)
    v_mfma_f32_32x32x16_bf16 v[192:207], v[56:59], a[72:75], v[192:207]
    ds_read_b64_tr_b16 v[56:57], v28 offset:49216
    ds_read_b64_tr_b16 v[58:59], v28 offset:49600
    v_lshrrev_b32 v118, 5, v1
    v_mfma_f32_32x32x16_bf16 v[208:223], v[60:63], a[72:75], v[208:223]
    ds_read_b64_tr_b16 v[60:61], v28 offset:50688
    ds_read_b64_tr_b16 v[62:63], v28 offset:51072
    v_mul_u32_u24 v118, 4608, v118
    buffer_load_dwordx4 a[164:167], v2, s[40:43], s28 offen offset:1024 sc0 sc1
    s_waitcnt lgkmcnt(12)
    v_mfma_f32_32x32x16_bf16 v[224:239], v[32:35], a[72:75], v[224:239]
    ds_read_b64_tr_b16 v[32:33], v28 offset:50720
    ds_read_b64_tr_b16 v[34:35], v28 offset:51104
    v_and_b32 v119, 31, v1
    v_lshl_add_u32 v118, v119, 4, v118
    v_mfma_f32_32x32x16_bf16 v[192:207], v[36:39], a[76:79], v[192:207]
    ds_read_b64_tr_b16 v[36:37], v28 offset:50752
    ds_read_b64_tr_b16 v[38:39], v28 offset:51136
    v_add_u32 v114, 131072, v118
    s_waitcnt lgkmcnt(12)
    v_mfma_f32_32x32x16_bf16 v[208:223], v[40:43], a[76:79], v[208:223]
    ds_read_b64_tr_b16 v[40:41], v28 offset:52224
    ds_read_b64_tr_b16 v[42:43], v28 offset:52608
    v_lshrrev_b32 v118, 1, v1
    v_mfma_f32_32x32x16_bf16 v[224:239], v[44:47], a[76:79], v[224:239]
    ds_read_b64_tr_b16 v[44:45], v28 offset:52256
    ds_read_b64_tr_b16 v[46:47], v28 offset:52640
    buffer_load_dwordx4 a[168:171], v2, s[40:43], s28 offen offset:2048 sc0 sc1
    v_lshlrev_b32 v118, 4, v118
    s_waitcnt vmcnt(12)
    s_waitcnt vmcnt(9)
    s_barrier
    s_waitcnt lgkmcnt(12)
    v_mfma_f32_32x32x16_bf16 v[192:207], v[48:51], a[80:83], v[192:207]
    ds_read_b64_tr_b16 v[48:49], v28 offset:52288
    ds_read_b64_tr_b16 v[50:51], v28 offset:52672
    v_mfma_f32_32x32x16_bf16 v[208:223], v[52:55], a[80:83], v[208:223]
    ds_read_b64_tr_b16 v[52:53], v28 offset:53760
    ds_read_b64_tr_b16 v[54:55], v28 offset:54144
    v_lshrrev_b32 v3, 1, v1
    v_lshlrev_b32 v3, 13, v3
    v_and_b32 v119, 1, v1
    s_waitcnt lgkmcnt(12)
    v_mfma_f32_32x32x16_bf16 v[224:239], v[56:59], a[80:83], v[224:239]
    ds_read_b64_tr_b16 v[56:57], v28 offset:53792
    ds_read_b64_tr_b16 v[58:59], v28 offset:54176
    v_and_b32 v8, 1, v1
    v_mul_u32_u24 v119, 4608, v119
    v_mfma_f32_32x32x16_bf16 v[192:207], v[60:63], a[84:87], v[192:207]
    ds_read_b64_tr_b16 v[60:61], v28 offset:53824
    ds_read_b64_tr_b16 v[62:63], v28 offset:54208
    v_lshl_add_u32 v3, v8, 4, v3
    v_add_u32 v118, v118, v119
    s_lshl_b32 s48, s60, 10
    s_waitcnt lgkmcnt(12)
    v_mfma_f32_32x32x16_bf16 v[208:223], v[32:35], a[84:87], v[208:223]
    ds_read_b64_tr_b16 v[32:33], v29 offset:0
    ds_read_b64_tr_b16 v[34:35], v29 offset:384
    s_lshl_b32 s100, s63, 5
    s_add_u32 s48, s48, 131584
    v_mfma_f32_32x32x16_bf16 v[224:239], v[36:39], a[84:87], v[224:239]
    ds_read_b64_tr_b16 v[36:37], v29 offset:32
    ds_read_b64_tr_b16 v[38:39], v29 offset:416
    buffer_load_dwordx4 a[172:175], v2, s[40:43], s28 offen offset:3072 sc0 sc1
    s_add_u32 s100, s100, 3145728
    s_waitcnt lgkmcnt(12)
    v_mfma_f32_32x32x16_bf16 v[192:207], v[40:43], a[88:91], v[192:207]
    ds_read_b64_tr_b16 v[40:41], v29 offset:64
    ds_read_b64_tr_b16 v[42:43], v29 offset:448
    s_lshl_b32 s99, s60, 19
    v_add_u32 v115, s48, v118
    v_mfma_f32_32x32x16_bf16 v[208:223], v[44:47], a[88:91], v[208:223]
    ds_read_b64_tr_b16 v[44:45], v29 offset:1536
    ds_read_b64_tr_b16 v[46:47], v29 offset:1920
    v_and_b32 v122, 15, v1
    buffer_load_dwordx4 a[176:179], v253, s[40:43], s28 offen offset:0 sc0 sc1
    s_waitcnt lgkmcnt(12)
    v_mfma_f32_32x32x16_bf16 v[224:239], v[48:51], a[88:91], v[224:239]
    ds_read_b64_tr_b16 v[48:49], v29 offset:1568
    ds_read_b64_tr_b16 v[50:51], v29 offset:1952
    s_add_u32 s100, s100, s99
    v_lshrrev_b32 v123, 4, v1
    v_mfma_f32_32x32x16_bf16 v[192:207], v[52:55], a[92:95], v[192:207]
    ds_read_b64_tr_b16 v[52:53], v29 offset:1600
    ds_read_b64_tr_b16 v[54:55], v29 offset:1984
    buffer_load_dwordx4 v[8:11], v3, s[40:43], s100 offen sc0 sc1
    v_and_b32 v118, 3, v122
    s_waitcnt lgkmcnt(12)
    v_mfma_f32_32x32x16_bf16 v[208:223], v[56:59], a[92:95], v[208:223]
    ds_read_b64_tr_b16 v[56:57], v29 offset:3072
    ds_read_b64_tr_b16 v[58:59], v29 offset:3456
    s_add_u32 s100, s100, 262144
    v_mul_u32_u24 v118, 4160, v118
    v_mfma_f32_32x32x16_bf16 v[224:239], v[60:63], a[92:95], v[224:239]
    ds_read_b64_tr_b16 v[60:61], v29 offset:3104
    ds_read_b64_tr_b16 v[62:63], v29 offset:3488
    buffer_load_dwordx4 v[12:15], v3, s[40:43], s100 offen sc0 sc1
    v_lshrrev_b32 v119, 1, v123
    s_waitcnt lgkmcnt(12)
    v_mfma_f32_32x32x16_bf16 v[192:207], v[32:35], a[96:99], v[192:207]
    ds_read_b64_tr_b16 v[32:33], v29 offset:3136
    ds_read_b64_tr_b16 v[34:35], v29 offset:3520
    v_lshlrev_b32 v119, 2, v119
    v_and_b32 v20, 1, v123
    v_mfma_f32_32x32x16_bf16 v[208:223], v[36:39], a[96:99], v[208:223]
    ds_read_b64_tr_b16 v[36:37], v29 offset:4608
    ds_read_b64_tr_b16 v[38:39], v29 offset:4992
    buffer_load_dwordx4 a[180:183], v253, s[40:43], s28 offen offset:1024 sc0 sc1
    v_lshlrev_b32 v20, 1, v20
    s_waitcnt lgkmcnt(12)
    v_mfma_f32_32x32x16_bf16 v[224:239], v[40:43], a[96:99], v[224:239]
    ds_read_b64_tr_b16 v[40:41], v29 offset:4640
    ds_read_b64_tr_b16 v[42:43], v29 offset:5024
    v_sub_u32 v119, v119, v20
    v_lshrrev_b32 v20, 2, v122
    v_mfma_f32_32x32x16_bf16 v[192:207], v[44:47], a[100:103], v[192:207]
    ds_read_b64_tr_b16 v[44:45], v29 offset:4672
    ds_read_b64_tr_b16 v[46:47], v29 offset:5056
    buffer_load_dwordx4 a[184:187], v253, s[40:43], s28 offen offset:2048 sc0 sc1
    v_add_u32 v119, v119, v20
    s_waitcnt lgkmcnt(12)
    v_mfma_f32_32x32x16_bf16 v[208:223], v[48:51], a[100:103], v[208:223]
    ds_read_b64_tr_b16 v[48:49], v29 offset:16384
    ds_read_b64_tr_b16 v[50:51], v29 offset:16768
    v_add_u32 v119, 3, v119
    v_lshl_add_u32 v118, v119, 3, v118
    v_mfma_f32_32x32x16_bf16 v[224:239], v[52:55], a[100:103], v[224:239]
    ds_read_b64_tr_b16 v[52:53], v29 offset:16416
    ds_read_b64_tr_b16 v[54:55], v29 offset:16800
    s_mul_i32 s48, s82, 16640
    buffer_load_dwordx4 a[188:191], v253, s[40:43], s28 offen offset:3072 sc0 sc1
    s_waitcnt lgkmcnt(12)
    v_mfma_f32_32x32x16_bf16 v[192:207], v[56:59], a[104:107], v[192:207]
    ds_read_b64_tr_b16 v[56:57], v29 offset:16448
    ds_read_b64_tr_b16 v[58:59], v29 offset:16832
    s_lshl_b32 s74, s81, 8
    s_add_u32 s48, s48, s74
    v_mfma_f32_32x32x16_bf16 v[208:223], v[60:63], a[104:107], v[208:223]
    ds_read_b64_tr_b16 v[60:61], v29 offset:17920
    ds_read_b64_tr_b16 v[62:63], v29 offset:18304
    s_add_u32 s48, s48, 94336
    v_add_u32 v20, s48, v118
    v_lshrrev_b32 v119, 1, v123
    s_waitcnt lgkmcnt(12)
    v_mfma_f32_32x32x16_bf16 v[224:239], v[32:35], a[104:107], v[224:239]
    ds_read_b64_tr_b16 v[32:33], v29 offset:17952
    ds_read_b64_tr_b16 v[34:35], v29 offset:18336
    buffer_load_dwordx4 a[192:195], v2, s[40:43], s29 offen offset:0 sc0 sc1
    v_mfma_f32_32x32x16_bf16 v[192:207], v[36:39], a[108:111], v[192:207]
    ds_read_b64_tr_b16 v[36:37], v29 offset:17984
    ds_read_b64_tr_b16 v[38:39], v29 offset:18368
    v_sub_u32 v119, v122, v119
    v_lshlrev_b32 v119, 5, v119
    s_waitcnt lgkmcnt(12)
    v_mfma_f32_32x32x16_bf16 v[208:223], v[40:43], a[108:111], v[208:223]
    ds_read_b64_tr_b16 v[40:41], v29 offset:19456
    ds_read_b64_tr_b16 v[42:43], v29 offset:19840
    v_and_b32 v118, 1, v123
    v_mfma_f32_32x32x16_bf16 v[224:239], v[44:47], a[108:111], v[224:239]
    ds_read_b64_tr_b16 v[44:45], v29 offset:19488
    ds_read_b64_tr_b16 v[46:47], v29 offset:19872
    v_lshl_add_u32 v119, v118, 4, v119
    buffer_load_dwordx4 a[196:199], v2, s[40:43], s29 offen offset:1024 sc0 sc1
    s_waitcnt lgkmcnt(12)
    v_mfma_f32_32x32x16_bf16 v[192:207], v[48:51], a[112:115], v[192:207]
    ds_read_b64_tr_b16 v[48:49], v29 offset:19520
    ds_read_b64_tr_b16 v[50:51], v29 offset:19904
    s_mul_i32 s48, s82, 4608
    s_add_u32 s48, s48, 131392
    v_mfma_f32_32x32x16_bf16 v[208:223], v[52:55], a[112:115], v[208:223]
    ds_read_b64_tr_b16 v[52:53], v29 offset:20992
    ds_read_b64_tr_b16 v[54:55], v29 offset:21376
    s_lshl_b32 s74, s81, 8
    s_waitcnt lgkmcnt(12)
    v_mfma_f32_32x32x16_bf16 v[224:239], v[56:59], a[112:115], v[224:239]
    ds_read_b64_tr_b16 v[56:57], v29 offset:21024
    ds_read_b64_tr_b16 v[58:59], v29 offset:21408
    s_sub_u32 s48, s48, s74
    v_mfma_f32_32x32x16_bf16 v[192:207], v[60:63], a[116:119], v[192:207]
    ds_read_b64_tr_b16 v[60:61], v29 offset:21056
    ds_read_b64_tr_b16 v[62:63], v29 offset:21440
    buffer_load_dwordx4 a[200:203], v2, s[40:43], s29 offen offset:2048 sc0 sc1
    v_add_u32 v21, s48, v119
    s_waitcnt lgkmcnt(12)
    v_mfma_f32_32x32x16_bf16 v[208:223], v[32:35], a[116:119], v[208:223]
    v_lshlrev_b32 v245, 5, v122
    v_mfma_f32_32x32x16_bf16 v[224:239], v[36:39], a[116:119], v[224:239]
    v_lshl_add_u32 v245, v123, 3, v245
    s_mul_i32 s48, s82, 4608
    s_waitcnt lgkmcnt(8)
    v_mfma_f32_32x32x16_bf16 v[192:207], v[40:43], a[120:123], v[192:207]
    buffer_load_dwordx4 a[204:207], v2, s[40:43], s29 offen offset:3072 sc0 sc1
    s_lshl_b32 s74, s81, 11
    v_mfma_f32_32x32x16_bf16 v[208:223], v[44:47], a[120:123], v[208:223]
    s_add_u32 s48, s48, s74
    s_waitcnt lgkmcnt(4)
    v_mfma_f32_32x32x16_bf16 v[224:239], v[48:51], a[120:123], v[224:239]
    s_add_u32 s48, s48, 131584
    v_mfma_f32_32x32x16_bf16 v[192:207], v[52:55], a[124:127], v[192:207]
    v_add_u32 v246, s48, v245
    s_waitcnt lgkmcnt(0)
    v_mfma_f32_32x32x16_bf16 v[208:223], v[56:59], a[124:127], v[208:223]
    v_mfma_f32_32x32x16_bf16 v[224:239], v[60:63], a[124:127], v[224:239]
    s_nop 9
    v_pk_mul_f32 v[64:65], v[192:193], v[192:193]
    v_pk_mul_f32 v[66:67], v[194:195], v[194:195]
    v_pk_mul_f32 v[68:69], v[196:197], v[196:197]
    v_pk_mul_f32 v[70:71], v[198:199], v[198:199]
    v_pk_fma_f32 v[64:65], v[64:65], s[86:87], v[120:121]
    buffer_load_dwordx4 a[208:211], v253, s[40:43], s29 offen offset:0 sc0 sc1
    v_pk_fma_f32 v[66:67], v[66:67], s[86:87], v[120:121]
    v_pk_fma_f32 v[68:69], v[68:69], s[86:87], v[120:121]
    v_pk_fma_f32 v[70:71], v[70:71], s[86:87], v[120:121]
    v_pk_mul_f32 v[64:65], v[64:65], v[192:193]
    v_pk_mul_f32 v[66:67], v[66:67], v[194:195]
    v_pk_mul_f32 v[68:69], v[68:69], v[196:197]
    v_pk_mul_f32 v[70:71], v[70:71], v[198:199]
    v_exp_f32 v64, v64
    v_exp_f32 v65, v65
    v_exp_f32 v66, v66
    v_exp_f32 v67, v67
    v_exp_f32 v68, v68
    v_exp_f32 v69, v69
    v_exp_f32 v70, v70
    v_exp_f32 v71, v71
    buffer_load_dwordx4 a[212:215], v253, s[40:43], s29 offen offset:1024 sc0 sc1
    v_pk_mul_f32 v[192:193], v[192:193], v[200:201]
    v_pk_mul_f32 v[194:195], v[194:195], v[202:203]
    v_pk_mul_f32 v[196:197], v[196:197], v[204:205]
    v_pk_mul_f32 v[198:199], v[198:199], v[206:207]
    v_pk_add_f32 v[64:65], v[64:65], 1.0 op_sel_hi:[1,0]
    v_pk_add_f32 v[66:67], v[66:67], 1.0 op_sel_hi:[1,0]
    v_pk_add_f32 v[68:69], v[68:69], 1.0 op_sel_hi:[1,0]
    v_pk_add_f32 v[70:71], v[70:71], 1.0 op_sel_hi:[1,0]
    v_rcp_f32 v64, v64
    v_rcp_f32 v65, v65
    v_rcp_f32 v66, v66
    v_rcp_f32 v67, v67
    v_rcp_f32 v68, v68
    v_rcp_f32 v69, v69
    v_rcp_f32 v70, v70
    v_rcp_f32 v71, v71
    buffer_load_dwordx4 a[216:219], v253, s[40:43], s29 offen offset:2048 sc0 sc1
    v_pk_mul_f32 v[192:193], v[192:193], v[64:65]
    v_pk_mul_f32 v[194:195], v[194:195], v[66:67]
    v_pk_mul_f32 v[196:197], v[196:197], v[68:69]
    v_pk_mul_f32 v[198:199], v[198:199], v[70:71]
    v_cvt_pk_bf16_f32 v80, v192, v193
    v_cvt_pk_bf16_f32 v81, v194, v195
    v_cvt_pk_bf16_f32 v82, v196, v197
    v_cvt_pk_bf16_f32 v83, v198, v199
    buffer_store_dwordx4 v[80:83], v2, s[40:43], s0 offen offset:0 sc0 sc1
    v_pk_mul_f32 v[72:73], v[208:209], v[208:209]
    v_pk_mul_f32 v[74:75], v[210:211], v[210:211]
    v_pk_mul_f32 v[76:77], v[212:213], v[212:213]
    v_pk_mul_f32 v[78:79], v[214:215], v[214:215]
    v_pk_fma_f32 v[72:73], v[72:73], s[86:87], v[120:121]
    v_pk_fma_f32 v[74:75], v[74:75], s[86:87], v[120:121]
    v_pk_fma_f32 v[76:77], v[76:77], s[86:87], v[120:121]
    buffer_load_dwordx4 a[220:223], v253, s[40:43], s29 offen offset:3072 sc0 sc1
    v_pk_fma_f32 v[78:79], v[78:79], s[86:87], v[120:121]
    v_pk_mul_f32 v[72:73], v[72:73], v[208:209]
    v_pk_mul_f32 v[74:75], v[74:75], v[210:211]
    v_pk_mul_f32 v[76:77], v[76:77], v[212:213]
    v_pk_mul_f32 v[78:79], v[78:79], v[214:215]
    v_exp_f32 v72, v72
    v_exp_f32 v73, v73
    v_exp_f32 v74, v74
    v_exp_f32 v75, v75
    v_exp_f32 v76, v76
    v_exp_f32 v77, v77
    v_exp_f32 v78, v78
    v_exp_f32 v79, v79
    v_pk_mul_f32 v[208:209], v[208:209], v[216:217]
    v_pk_mul_f32 v[210:211], v[210:211], v[218:219]
    v_pk_mul_f32 v[212:213], v[212:213], v[220:221]
    buffer_load_dwordx4 a[224:227], v2, s[40:43], s30 offen offset:0 sc0 sc1
    v_pk_mul_f32 v[214:215], v[214:215], v[222:223]
    v_pk_add_f32 v[72:73], v[72:73], 1.0 op_sel_hi:[1,0]
    v_pk_add_f32 v[74:75], v[74:75], 1.0 op_sel_hi:[1,0]
    v_pk_add_f32 v[76:77], v[76:77], 1.0 op_sel_hi:[1,0]
    v_pk_add_f32 v[78:79], v[78:79], 1.0 op_sel_hi:[1,0]
    v_rcp_f32 v72, v72
    v_rcp_f32 v73, v73
    v_rcp_f32 v74, v74
    v_rcp_f32 v75, v75
    v_rcp_f32 v76, v76
    v_rcp_f32 v77, v77
    v_rcp_f32 v78, v78
    v_rcp_f32 v79, v79
    v_pk_mul_f32 v[208:209], v[208:209], v[72:73]
    v_pk_mul_f32 v[210:211], v[210:211], v[74:75]
    v_pk_mul_f32 v[212:213], v[212:213], v[76:77]
    buffer_load_dwordx4 a[228:231], v2, s[40:43], s30 offen offset:1024 sc0 sc1
    v_pk_mul_f32 v[214:215], v[214:215], v[78:79]
    v_cvt_pk_bf16_f32 v84, v208, v209
    v_cvt_pk_bf16_f32 v85, v210, v211
    v_cvt_pk_bf16_f32 v86, v212, v213
    v_cvt_pk_bf16_f32 v87, v214, v215
    buffer_store_dwordx4 v[84:87], v2, s[40:43], s0 offen offset:1024 sc0 sc1
    v_pk_mul_f32 v[64:65], v[224:225], v[224:225]
    v_pk_mul_f32 v[66:67], v[226:227], v[226:227]
    v_pk_mul_f32 v[68:69], v[228:229], v[228:229]
    v_pk_mul_f32 v[70:71], v[230:231], v[230:231]
    v_pk_fma_f32 v[64:65], v[64:65], s[86:87], v[120:121]
    v_pk_fma_f32 v[66:67], v[66:67], s[86:87], v[120:121]
    v_pk_fma_f32 v[68:69], v[68:69], s[86:87], v[120:121]
    v_pk_fma_f32 v[70:71], v[70:71], s[86:87], v[120:121]
    v_pk_mul_f32 v[64:65], v[64:65], v[224:225]
    v_pk_mul_f32 v[66:67], v[66:67], v[226:227]
    buffer_load_dwordx4 a[232:235], v2, s[40:43], s30 offen offset:2048 sc0 sc1
    v_pk_mul_f32 v[68:69], v[68:69], v[228:229]
    v_pk_mul_f32 v[70:71], v[70:71], v[230:231]
    v_exp_f32 v64, v64
    v_exp_f32 v65, v65
    v_exp_f32 v66, v66
    v_exp_f32 v67, v67
    v_exp_f32 v68, v68
    v_exp_f32 v69, v69
    v_exp_f32 v70, v70
    v_exp_f32 v71, v71
    v_pk_mul_f32 v[224:225], v[224:225], v[232:233]
    v_pk_mul_f32 v[226:227], v[226:227], v[234:235]
    v_pk_mul_f32 v[228:229], v[228:229], v[236:237]
    v_pk_mul_f32 v[230:231], v[230:231], v[238:239]
    v_pk_add_f32 v[64:65], v[64:65], 1.0 op_sel_hi:[1,0]
    v_pk_add_f32 v[66:67], v[66:67], 1.0 op_sel_hi:[1,0]
    buffer_load_dwordx4 a[236:239], v2, s[40:43], s30 offen offset:3072 sc0 sc1
    v_pk_add_f32 v[68:69], v[68:69], 1.0 op_sel_hi:[1,0]
    v_pk_add_f32 v[70:71], v[70:71], 1.0 op_sel_hi:[1,0]
    v_rcp_f32 v64, v64
    v_rcp_f32 v65, v65
    v_rcp_f32 v66, v66
    v_rcp_f32 v67, v67
    v_rcp_f32 v68, v68
    v_rcp_f32 v69, v69
    v_rcp_f32 v70, v70
    v_rcp_f32 v71, v71
    v_pk_mul_f32 v[224:225], v[224:225], v[64:65]
    v_pk_mul_f32 v[226:227], v[226:227], v[66:67]
    v_pk_mul_f32 v[228:229], v[228:229], v[68:69]
    v_pk_mul_f32 v[230:231], v[230:231], v[70:71]
    v_cvt_pk_bf16_f32 v80, v224, v225
    v_cvt_pk_bf16_f32 v81, v226, v227
    v_cvt_pk_bf16_f32 v82, v228, v229
    v_cvt_pk_bf16_f32 v83, v230, v231
    buffer_store_dwordx4 v[80:83], v2, s[40:43], s0 offen offset:2048 sc0 sc1
    v_mov_b32 v16, 0
    v_mov_b32 v17, 0
    v_mov_b32 v18, 0
    buffer_load_dwordx4 a[240:243], v253, s[40:43], s30 offen offset:0 sc0 sc1
    v_mov_b32 v19, 0
    buffer_load_dwordx4 a[244:247], v253, s[40:43], s30 offen offset:1024 sc0 sc1
    s_mov_b64 exec, 0xff
    ds_write_b128 v113, v[16:19]
    s_mov_b64 exec, -1
    buffer_load_dwordx4 a[248:251], v253, s[40:43], s30 offen offset:2048 sc0 sc1
    s_nop 0
    ds_write_b128 v112, v[128:131] offset:0
    buffer_load_dwordx4 a[252:255], v253, s[40:43], s30 offen offset:3072 sc0 sc1
    ds_write_b128 v112, v[132:135] offset:16
    ds_write_b128 v112, v[136:139] offset:4160
    buffer_load_dwordx4 a[0:3], v2, s[40:43], s31 offen offset:0 sc0 sc1
    ds_write_b128 v112, v[140:143] offset:4176
    buffer_load_dwordx4 a[4:7], v2, s[40:43], s31 offen offset:1024 sc0 sc1
    ds_write_b128 v112, v[144:147] offset:8320
    buffer_load_dwordx4 a[8:11], v2, s[40:43], s31 offen offset:2048 sc0 sc1
    ds_write_b128 v112, v[148:151] offset:8336
    buffer_load_dwordx4 a[12:15], v2, s[40:43], s31 offen offset:3072 sc0 sc1
    ds_write_b128 v112, v[152:155] offset:12480
    ds_write_b128 v112, v[156:159] offset:12496
    s_lshl_b32 s71, s64, 8
    s_lshl_b32 s72, s65, 2
    s_add_u32 s71, s71, s72
    s_add_u32 s71, s71, 8192
    s_cmp_eq_u32 s2, 0
    s_cselect_b32 s70, s69, 0x7ff00000
    v_mov_b32 v244, s70
    v_mov_b32_e64 v240, s68
    s_waitcnt vmcnt(26)
    ds_write_b128 v115, v[8:11]
    ds_write_b128 v115, v[12:15] offset:512
    ds_write_b128 v114, v[16:19]
    s_mov_b64 exec, 1
    buffer_store_dword v240, v244, s[40:43], 0 offen sc0 sc1
    s_mov_b64 exec, -1
    s_waitcnt vmcnt(9)
    s_waitcnt lgkmcnt(0)
    s_barrier
    s_add_u32 s99, s71, s69
    v_mov_b32 v254, s99
    v_mov_b32 v255, s68
    s_mov_b64 exec, 1
    buffer_store_dword v255, v254, s[40:43], 0 offen sc0 sc1
    s_mov_b64 exec, -1
    ds_read_b64 v[64:65], v20 offset:8
    ds_read_b64 v[66:67], v20 offset:0
    ds_read_b128 v[96:99], v21 offset:192
    ds_read_b64 v[68:69], v20 offset:520
    ds_read_b64 v[70:71], v20 offset:512
    ds_read_b128 v[100:103], v21 offset:704
    ds_read_b64 v[72:73], v20 offset:1032
    ds_read_b64 v[74:75], v20 offset:1024
    ds_read_b128 v[104:107], v21 offset:1216
    ds_read_b64 v[76:77], v20 offset:1544
    ds_read_b64 v[78:79], v20 offset:1536
    ds_read_b128 v[108:111], v21 offset:1728
    ds_read_b64 v[80:81], v20 offset:2056
    ds_read_b64 v[82:83], v20 offset:2048
    ds_read_b128 v[112:115], v21 offset:2240
    ds_read_b64 v[84:85], v20 offset:2568
    ds_read_b64 v[86:87], v20 offset:2560
    ds_read_b128 v[116:119], v21 offset:2752
    ds_read_b64 v[88:89], v20 offset:3080
    ds_read_b64 v[90:91], v20 offset:3072
    ds_read_b128 v[120:123], v21 offset:3264
    ds_read_b64 v[92:93], v20 offset:3592
    ds_read_b64 v[94:95], v20 offset:3584
    ds_read_b128 v[124:127], v21 offset:3776
    s_waitcnt lgkmcnt(15)
    v_mfma_f32_16x16x32_bf16 v[32:35], v[64:67], v[96:99], 0
    v_and_b32 v244, 3, v1
    v_lshlrev_b32 v244, 2, v244
    v_mfma_f32_16x16x32_bf16 v[36:39], v[64:67], v[100:103], 0
    s_lshr_b32 s100, s66, 1
    v_mfma_f32_16x16x32_bf16 v[36:39], v[68:71], v[96:99], v[36:39]
    s_lshl_b32 s100, s100, 8
    s_lshl_b32 s94, s60, 4
    v_mfma_f32_16x16x32_bf16 v[40:43], v[68:71], v[100:103], 0
    s_add_u32 s100, s100, s94
    v_mfma_f32_16x16x32_bf16 v[40:43], v[64:67], v[104:107], v[40:43]
    ds_read_b64 v[128:129], v20 offset:72
    ds_read_b64 v[130:131], v20 offset:64
    ds_read_b128 v[160:163], v21 offset:128
    v_mfma_f32_16x16x32_bf16 v[40:43], v[72:75], v[96:99], v[40:43]
    s_add_u32 s100, s100, 20480
    v_add_u32 v244, s100, v244
    buffer_load_dword v240, v244, s[40:43], 0 offen sc0 sc1
    v_mfma_f32_16x16x32_bf16 v[44:47], v[68:71], v[104:107], 0
    v_and_b32 v10, 31, v1
    v_lshrrev_b32 v11, 5, v1
    v_mfma_f32_16x16x32_bf16 v[44:47], v[72:75], v[100:103], v[44:47]
    v_lshlrev_b32 v12, 10, v10
    v_lshl_add_u32 v30, v11, 3, v12
    v_mfma_f32_16x16x32_bf16 v[48:51], v[72:75], v[104:107], 0
    ds_read_b64 v[132:133], v20 offset:584
    ds_read_b64 v[134:135], v20 offset:576
    ds_read_b128 v[164:167], v21 offset:640
    s_waitcnt lgkmcnt(15)
    v_mfma_f32_16x16x32_bf16 v[44:47], v[64:67], v[108:111], v[44:47]
    v_lshrrev_b32 v10, 2, v1
    v_lshlrev_b32 v10, 12, v10
    v_mfma_f32_16x16x32_bf16 v[44:47], v[76:79], v[96:99], v[44:47]
    v_and_b32 v11, 3, v1
    v_lshl_add_u32 v31, v11, 4, v10
    v_mfma_f32_16x16x32_bf16 v[48:51], v[68:71], v[108:111], v[48:51]
    s_lshl_b32 s99, s60, 11
    s_add_u32 s99, s99, 98304
    v_mfma_f32_16x16x32_bf16 v[48:51], v[76:79], v[100:103], v[48:51]
    ds_read_b64 v[136:137], v20 offset:1096
    ds_read_b64 v[138:139], v20 offset:1088
    ds_read_b128 v[168:171], v21 offset:1152
    v_mfma_f32_16x16x32_bf16 v[52:55], v[72:75], v[108:111], 0
    v_add_u32 v248, s99, v2
    v_lshrrev_b32 v10, 5, v1
    v_mfma_f32_16x16x32_bf16 v[52:55], v[76:79], v[104:107], v[52:55]
    v_lshlrev_b32 v10, 8, v10
    v_bfe_u32 v11, v1, 2, 2
    buffer_load_dwordx4 a[16:19], v253, s[40:43], s31 offen offset:0 sc0 sc1
    v_mfma_f32_16x16x32_bf16 v[56:59], v[76:79], v[108:111], 0
    v_lshl_add_u32 v10, v11, 6, v10
    v_bfe_u32 v11, v1, 4, 1
    v_mfma_f32_16x16x32_bf16 v[48:51], v[64:67], v[112:115], v[48:51]
    ds_read_b64 v[140:141], v20 offset:1608
    ds_read_b64 v[142:143], v20 offset:1600
    ds_read_b128 v[172:175], v21 offset:1664
    v_mfma_f32_16x16x32_bf16 v[48:51], v[80:83], v[96:99], v[48:51]
    v_lshl_add_u32 v10, v11, 5, v10
    v_and_b32 v11, 3, v1
    buffer_load_dwordx4 a[20:23], v253, s[40:43], s31 offen offset:1024 sc0 sc1
    v_mfma_f32_16x16x32_bf16 v[52:55], v[68:71], v[112:115], v[52:55]
    v_lshl_add_u32 v10, v11, 3, v10
    v_add_u32 v249, s99, v10
    v_mfma_f32_16x16x32_bf16 v[52:55], v[80:83], v[100:103], v[52:55]
    v_add_u32 v247, 114688, v2
    s_lshl_b32 s99, s66, 6
    v_mfma_f32_16x16x32_bf16 v[56:59], v[72:75], v[112:115], v[56:59]
    ds_read_b64 v[144:145], v20 offset:2120
    ds_read_b64 v[146:147], v20 offset:2112
    ds_read_b128 v[176:179], v21 offset:2176
    buffer_load_dwordx4 a[24:27], v253, s[40:43], s31 offen offset:2048 sc0 sc1
    v_mfma_f32_16x16x32_bf16 v[56:59], v[80:83], v[104:107], v[56:59]
    s_lshl_b32 s93, s81, 5
    s_add_u32 s99, s99, s93
    s_lshl_b32 s93, s99, 10
    s_lshl_b32 s99, s67, 7
    s_add_u32 s93, s93, s99
    s_lshl_b32 s99, s82, 6
    s_add_u32 s93, s93, s99
    v_mfma_f32_16x16x32_bf16 v[60:63], v[76:79], v[112:115], 0
    buffer_load_dwordx4 a[28:31], v253, s[40:43], s31 offen offset:3072 sc0 sc1
    v_mfma_f32_16x16x32_bf16 v[60:63], v[80:83], v[108:111], v[60:63]
    s_waitcnt lgkmcnt(15)
    v_mfma_f32_16x16x32_bf16 v[52:55], v[64:67], v[116:119], v[52:55]
    ds_read_b64 v[148:149], v20 offset:2632
    ds_read_b64 v[150:151], v20 offset:2624
    ds_read_b128 v[180:183], v21 offset:2688
    v_mfma_f32_16x16x32_bf16 v[52:55], v[84:87], v[96:99], v[52:55]
    v_mfma_f32_16x16x32_bf16 v[56:59], v[68:71], v[116:119], v[56:59]
    buffer_load_dwordx4 a[32:35], v2, s[40:43], s32 offen offset:0 sc0 sc1
    v_mfma_f32_16x16x32_bf16 v[56:59], v[84:87], v[100:103], v[56:59]
    v_mfma_f32_16x16x32_bf16 v[60:63], v[72:75], v[116:119], v[60:63]
    ds_read_b64 v[152:153], v20 offset:3144
    ds_read_b64 v[154:155], v20 offset:3136
    ds_read_b128 v[184:187], v21 offset:3200
    v_mfma_f32_16x16x32_bf16 v[60:63], v[84:87], v[104:107], v[60:63]
    v_mfma_f32_16x16x32_bf16 v[56:59], v[64:67], v[120:123], v[56:59]
    buffer_load_dwordx4 a[36:39], v2, s[40:43], s32 offen offset:1024 sc0 sc1
    v_mfma_f32_16x16x32_bf16 v[56:59], v[88:91], v[96:99], v[56:59]
    v_mfma_f32_16x16x32_bf16 v[60:63], v[68:71], v[120:123], v[60:63]
    ds_read_b64 v[156:157], v20 offset:3656
    ds_read_b64 v[158:159], v20 offset:3648
    ds_read_b128 v[188:191], v21 offset:3712
    v_mfma_f32_16x16x32_bf16 v[60:63], v[88:91], v[100:103], v[60:63]
    v_mfma_f32_16x16x32_bf16 v[60:63], v[64:67], v[124:127], v[60:63]
    buffer_load_dwordx4 a[40:43], v2, s[40:43], s32 offen offset:2048 sc0 sc1
    v_mfma_f32_16x16x32_bf16 v[60:63], v[92:95], v[96:99], v[60:63]
    s_waitcnt lgkmcnt(15)
    v_mfma_f32_16x16x32_bf16 v[32:35], v[128:131], v[160:163], v[32:35]
    v_mfma_f32_16x16x32_bf16 v[36:39], v[128:131], v[164:167], v[36:39]
    v_mfma_f32_16x16x32_bf16 v[36:39], v[132:135], v[160:163], v[36:39]
    buffer_load_dwordx4 a[44:47], v2, s[40:43], s32 offen offset:3072 sc0 sc1
    v_mfma_f32_16x16x32_bf16 v[40:43], v[132:135], v[164:167], v[40:43]
    v_mfma_f32_16x16x32_bf16 v[40:43], v[128:131], v[168:171], v[40:43]
    ds_read_b64 v[64:65], v20 offset:136
    ds_read_b64 v[66:67], v20 offset:128
    ds_read_b128 v[96:99], v21 offset:64
    v_mfma_f32_16x16x32_bf16 v[40:43], v[136:139], v[160:163], v[40:43]
    s_lshl_b32 s70, s60, 12
    v_mfma_f32_16x16x32_bf16 v[44:47], v[132:135], v[168:171], v[44:47]
    buffer_load_dwordx4 a[48:51], v253, s[40:43], s32 offen offset:0 sc0 sc1
    v_mfma_f32_16x16x32_bf16 v[44:47], v[136:139], v[164:167], v[44:47]
    s_add_u32 s70, s70, 143488
    v_mfma_f32_16x16x32_bf16 v[48:51], v[136:139], v[168:171], v[48:51]
    ds_read_b64 v[68:69], v20 offset:648
    ds_read_b64 v[70:71], v20 offset:640
    ds_read_b128 v[100:103], v21 offset:576
    s_waitcnt lgkmcnt(15)
    v_mfma_f32_16x16x32_bf16 v[44:47], v[128:131], v[172:175], v[44:47]
    v_mfma_f32_16x16x32_bf16 v[44:47], v[140:143], v[160:163], v[44:47]
    buffer_load_dwordx4 a[52:55], v253, s[40:43], s32 offen offset:1024 sc0 sc1
    v_mfma_f32_16x16x32_bf16 v[48:51], v[132:135], v[172:175], v[48:51]
    v_add_u32 v6, s70, v2
    v_mfma_f32_16x16x32_bf16 v[48:51], v[140:143], v[164:167], v[48:51]
    ds_read_b64 v[72:73], v20 offset:1160
    ds_read_b64 v[74:75], v20 offset:1152
    ds_read_b128 v[104:107], v21 offset:1088
    v_mfma_f32_16x16x32_bf16 v[52:55], v[136:139], v[172:175], v[52:55]
    v_mfma_f32_16x16x32_bf16 v[52:55], v[140:143], v[168:171], v[52:55]
    buffer_load_dwordx4 a[56:59], v253, s[40:43], s32 offen offset:2048 sc0 sc1
    v_mfma_f32_16x16x32_bf16 v[56:59], v[140:143], v[172:175], v[56:59]
    s_xor_b32 s70, s60, 1
    v_mfma_f32_16x16x32_bf16 v[48:51], v[128:131], v[176:179], v[48:51]
    ds_read_b64 v[76:77], v20 offset:1672
    ds_read_b64 v[78:79], v20 offset:1664
    ds_read_b128 v[108:111], v21 offset:1600
    v_mfma_f32_16x16x32_bf16 v[48:51], v[144:147], v[160:163], v[48:51]
    v_mfma_f32_16x16x32_bf16 v[52:55], v[132:135], v[176:179], v[52:55]
    buffer_load_dwordx4 a[60:63], v253, s[40:43], s32 offen offset:3072 sc0 sc1
    v_mfma_f32_16x16x32_bf16 v[52:55], v[144:147], v[164:167], v[52:55]
    s_lshl_b32 s70, s70, 12
    v_mfma_f32_16x16x32_bf16 v[56:59], v[136:139], v[176:179], v[56:59]
    ds_read_b64 v[80:81], v20 offset:2184
    ds_read_b64 v[82:83], v20 offset:2176
    ds_read_b128 v[112:115], v21 offset:2112
    v_mfma_f32_16x16x32_bf16 v[56:59], v[144:147], v[168:171], v[56:59]
    v_mfma_f32_16x16x32_bf16 v[60:63], v[140:143], v[176:179], v[60:63]
    buffer_load_dwordx4 a[64:67], v2, s[40:43], s33 offen offset:0 sc0 sc1
    v_mfma_f32_16x16x32_bf16 v[60:63], v[144:147], v[172:175], v[60:63]
    s_add_u32 s70, s70, 143488
    s_waitcnt lgkmcnt(15)
    v_mfma_f32_16x16x32_bf16 v[52:55], v[128:131], v[180:183], v[52:55]
    ds_read_b64 v[84:85], v20 offset:2696
    ds_read_b64 v[86:87], v20 offset:2688
    ds_read_b128 v[116:119], v21 offset:2624
    v_mfma_f32_16x16x32_bf16 v[52:55], v[148:151], v[160:163], v[52:55]
    v_mfma_f32_16x16x32_bf16 v[56:59], v[132:135], v[180:183], v[56:59]
    buffer_load_dwordx4 a[68:71], v2, s[40:43], s33 offen offset:1024 sc0 sc1
    v_mfma_f32_16x16x32_bf16 v[56:59], v[148:151], v[164:167], v[56:59]
    v_add_u32 v7, s70, v2
    v_mfma_f32_16x16x32_bf16 v[60:63], v[136:139], v[180:183], v[60:63]
    ds_read_b64 v[88:89], v20 offset:3208
    ds_read_b64 v[90:91], v20 offset:3200
    ds_read_b128 v[120:123], v21 offset:3136
    v_mfma_f32_16x16x32_bf16 v[60:63], v[148:151], v[168:171], v[60:63]
    v_mfma_f32_16x16x32_bf16 v[56:59], v[128:131], v[184:187], v[56:59]
    buffer_load_dwordx4 a[72:75], v2, s[40:43], s33 offen offset:2048 sc0 sc1
    v_mfma_f32_16x16x32_bf16 v[56:59], v[152:155], v[160:163], v[56:59]
    s_lshl_b32 s72, s77, 16
    v_mfma_f32_16x16x32_bf16 v[60:63], v[132:135], v[184:187], v[60:63]
    ds_read_b64 v[92:93], v20 offset:3720
    ds_read_b64 v[94:95], v20 offset:3712
    ds_read_b128 v[124:127], v21 offset:3648
    v_mfma_f32_16x16x32_bf16 v[60:63], v[152:155], v[164:167], v[60:63]
    v_mfma_f32_16x16x32_bf16 v[60:63], v[128:131], v[188:191], v[60:63]
    buffer_load_dwordx4 a[76:79], v2, s[40:43], s33 offen offset:3072 sc0 sc1
    v_mfma_f32_16x16x32_bf16 v[60:63], v[156:159], v[160:163], v[60:63]
    s_and_b32 s73, s77, s78
    s_waitcnt lgkmcnt(15)
    v_mfma_f32_16x16x32_bf16 v[32:35], v[64:67], v[96:99], v[32:35]
    v_mfma_f32_16x16x32_bf16 v[36:39], v[64:67], v[100:103], v[36:39]
    s_cmp_eq_u32 s82, 0
    s_cselect_b32 s84, s72, s73
    v_mfma_f32_16x16x32_bf16 v[36:39], v[68:71], v[96:99], v[36:39]
    buffer_load_dwordx4 a[80:83], v253, s[40:43], s33 offen offset:0 sc0 sc1
    v_mfma_f32_16x16x32_bf16 v[40:43], v[68:71], v[100:103], v[40:43]
    v_mfma_f32_16x16x32_bf16 v[40:43], v[64:67], v[104:107], v[40:43]
    ds_read_b64 v[128:129], v20 offset:200
    ds_read_b64 v[130:131], v20 offset:192
    ds_read_b128 v[160:163], v21 offset:0
    v_mfma_f32_16x16x32_bf16 v[40:43], v[72:75], v[96:99], v[40:43]
    s_lshl_b32 s71, s81, 11
    v_mfma_f32_16x16x32_bf16 v[44:47], v[68:71], v[104:107], v[44:47]
    buffer_load_dwordx4 a[84:87], v253, s[40:43], s33 offen offset:1024 sc0 sc1
    v_mfma_f32_16x16x32_bf16 v[44:47], v[72:75], v[100:103], v[44:47]
    v_mfma_f32_16x16x32_bf16 v[48:51], v[72:75], v[104:107], v[48:51]
    ds_read_b64 v[132:133], v20 offset:712
    ds_read_b64 v[134:135], v20 offset:704
    ds_read_b128 v[164:167], v21 offset:512
    s_waitcnt lgkmcnt(15)
    v_mfma_f32_16x16x32_bf16 v[44:47], v[64:67], v[108:111], v[44:47]
    s_lshl_b32 s70, s63, 1
    v_mfma_f32_16x16x32_bf16 v[44:47], v[76:79], v[96:99], v[44:47]
    buffer_load_dwordx4 a[88:91], v253, s[40:43], s33 offen offset:2048 sc0 sc1
    v_mfma_f32_16x16x32_bf16 v[48:51], v[68:71], v[108:111], v[48:51]
    v_mfma_f32_16x16x32_bf16 v[48:51], v[76:79], v[100:103], v[48:51]
    ds_read_b64 v[136:137], v20 offset:1224
    ds_read_b64 v[138:139], v20 offset:1216
    ds_read_b128 v[168:171], v21 offset:1024
    v_mfma_f32_16x16x32_bf16 v[52:55], v[72:75], v[108:111], v[52:55]
    s_add_u32 s70, s70, s82
    v_mfma_f32_16x16x32_bf16 v[52:55], v[76:79], v[104:107], v[52:55]
    buffer_load_dwordx4 a[92:95], v253, s[40:43], s33 offen offset:3072 sc0 sc1
    s_waitcnt vmcnt(20)
    v_cmp_ne_u32 vcc, s68, v240
    s_nop 4
    s_cmp_eq_u64 vcc, 0
    s_cbranch_scc0 L_slow_g2a
L_ok_g2a:
    v_mfma_f32_16x16x32_bf16 v[56:59], v[76:79], v[108:111], v[56:59]
    v_mfma_f32_16x16x32_bf16 v[48:51], v[64:67], v[112:115], v[48:51]
    ds_read_b64 v[140:141], v20 offset:1736
    ds_read_b64 v[142:143], v20 offset:1728
    ds_read_b128 v[172:175], v21 offset:1536
    v_mfma_f32_16x16x32_bf16 v[48:51], v[80:83], v[96:99], v[48:51]
    buffer_load_dwordx4 a[96:99], v2, s[40:43], s20 offen offset:0 sc0 sc1
    v_mfma_f32_16x16x32_bf16 v[52:55], v[68:71], v[112:115], v[52:55]
    s_lshl_b32 s70, s70, 12
    v_mfma_f32_16x16x32_bf16 v[52:55], v[80:83], v[100:103], v[52:55]
    v_mfma_f32_16x16x32_bf16 v[56:59], v[72:75], v[112:115], v[56:59]
    ds_read_b64 v[144:145], v20 offset:2248
    ds_read_b64 v[146:147], v20 offset:2240
    ds_read_b128 v[176:179], v21 offset:2048
    v_mfma_f32_16x16x32_bf16 v[56:59], v[80:83], v[104:107], v[56:59]
    buffer_load_dwordx4 a[100:103], v247, s[40:43], s20 offen offset:0 sc0 sc1
    v_mfma_f32_16x16x32_bf16 v[60:63], v[76:79], v[112:115], v[60:63]
    s_add_u32 s70, s70, s71
    v_mfma_f32_16x16x32_bf16 v[60:63], v[80:83], v[108:111], v[60:63]
    s_waitcnt lgkmcnt(15)
    v_mfma_f32_16x16x32_bf16 v[52:55], v[64:67], v[116:119], v[52:55]
    ds_read_b64 v[148:149], v20 offset:2760
    ds_read_b64 v[150:151], v20 offset:2752
    ds_read_b128 v[180:183], v21 offset:2560
    v_mfma_f32_16x16x32_bf16 v[52:55], v[84:87], v[96:99], v[52:55]
    buffer_load_dwordx4 a[104:107], v2, s[40:43], s20 offen offset:1024 sc0 sc1
    v_mfma_f32_16x16x32_bf16 v[56:59], v[68:71], v[116:119], v[56:59]
    s_add_u32 s70, s70, 13631488
    v_mfma_f32_16x16x32_bf16 v[56:59], v[84:87], v[100:103], v[56:59]
    v_mfma_f32_16x16x32_bf16 v[60:63], v[72:75], v[116:119], v[60:63]
    ds_read_b64 v[152:153], v20 offset:3272
    ds_read_b64 v[154:155], v20 offset:3264
    ds_read_b128 v[184:187], v21 offset:3072
    v_mfma_f32_16x16x32_bf16 v[60:63], v[84:87], v[104:107], v[60:63]
    buffer_load_dwordx4 a[108:111], v247, s[40:43], s20 offen offset:1024 sc0 sc1
    v_mfma_f32_16x16x32_bf16 v[56:59], v[64:67], v[120:123], v[56:59]
    v_mfma_f32_16x16x32_bf16 v[56:59], v[88:91], v[96:99], v[56:59]
    v_mfma_f32_16x16x32_bf16 v[60:63], v[68:71], v[120:123], v[60:63]
    ds_read_b64 v[156:157], v20 offset:3784
    ds_read_b64 v[158:159], v20 offset:3776
    ds_read_b128 v[188:191], v21 offset:3584
    v_mfma_f32_16x16x32_bf16 v[60:63], v[88:91], v[100:103], v[60:63]
    buffer_load_dwordx4 a[112:115], v2, s[40:43], s20 offen offset:2048 sc0 sc1
    v_mfma_f32_16x16x32_bf16 v[60:63], v[64:67], v[124:127], v[60:63]
    v_mfma_f32_16x16x32_bf16 v[60:63], v[92:95], v[96:99], v[60:63]
    s_waitcnt lgkmcnt(15)
    v_mfma_f32_16x16x32_bf16 v[32:35], v[128:131], v[160:163], v[32:35]
    v_mfma_f32_16x16x32_bf16 v[36:39], v[128:131], v[164:167], v[36:39]
    buffer_load_dwordx4 a[116:119], v247, s[40:43], s20 offen offset:2048 sc0 sc1
    v_mfma_f32_16x16x32_bf16 v[36:39], v[132:135], v[160:163], v[36:39]
    ds_read_b64 v[80:81], v246 offset:0
    ds_read_b64 v[82:83], v246 offset:512
    v_mfma_f32_16x16x32_bf16 v[40:43], v[132:135], v[164:167], v[40:43]
    ds_read_b64 v[84:85], v246 offset:1024
    v_mfma_f32_16x16x32_bf16 v[40:43], v[128:131], v[168:171], v[40:43]
    ds_read_b64 v[86:87], v246 offset:1536
    v_mfma_f32_16x16x32_bf16 v[40:43], v[136:139], v[160:163], v[40:43]
    buffer_load_dwordx4 a[120:123], v2, s[40:43], s20 offen offset:3072 sc0 sc1
    v_mfma_f32_16x16x32_bf16 v[44:47], v[132:135], v[168:171], v[44:47]
    s_waitcnt lgkmcnt(3)
    v_lshlrev_b32 v64, 16, v80
    v_mfma_f32_16x16x32_bf16 v[44:47], v[136:139], v[164:167], v[44:47]
    v_and_b32 v65, s78, v80
    v_mul_f32 v64, s84, v64
    v_mfma_f32_16x16x32_bf16 v[48:51], v[136:139], v[168:171], v[48:51]
    v_mul_f32 v65, s84, v65
    v_mfma_f32_16x16x32_bf16 v[44:47], v[128:131], v[172:175], v[44:47]
    buffer_load_dwordx4 a[124:127], v247, s[40:43], s20 offen offset:3072 sc0 sc1
    v_mfma_f32_16x16x32_bf16 v[44:47], v[140:143], v[160:163], v[44:47]
    v_lshlrev_b32 v66, 16, v81
    v_and_b32 v67, s78, v81
    v_mfma_f32_16x16x32_bf16 v[48:51], v[132:135], v[172:175], v[48:51]
    v_mul_f32 v66, s84, v66
    v_mul_f32 v67, s84, v67
    v_mfma_f32_16x16x32_bf16 v[48:51], v[140:143], v[164:167], v[48:51]
    s_waitcnt lgkmcnt(2)
    v_mfma_f32_16x16x32_bf16 v[52:55], v[136:139], v[172:175], v[52:55]
    buffer_load_dwordx4 v[192:195], v2, s[40:43], s21 offen offset:0 sc0 sc1
    v_mfma_f32_16x16x32_bf16 v[52:55], v[140:143], v[168:171], v[52:55]
    v_lshlrev_b32 v68, 16, v82
    v_and_b32 v69, s78, v82
    v_mfma_f32_16x16x32_bf16 v[56:59], v[140:143], v[172:175], v[56:59]
    v_mul_f32 v68, s84, v68
    v_mfma_f32_16x16x32_bf16 v[48:51], v[128:131], v[176:179], v[48:51]
    v_mul_f32 v69, s84, v69
    v_lshlrev_b32 v70, 16, v83
    v_mfma_f32_16x16x32_bf16 v[48:51], v[144:147], v[160:163], v[48:51]
    buffer_load_dwordx4 v[196:199], v247, s[40:43], s21 offen offset:0 sc0 sc1
    v_mfma_f32_16x16x32_bf16 v[52:55], v[132:135], v[176:179], v[52:55]
    v_and_b32 v244, 3, v1
    v_and_b32 v71, s78, v83
    v_mfma_f32_16x16x32_bf16 v[52:55], v[144:147], v[164:167], v[52:55]
    v_mul_f32 v70, s84, v70
    v_lshlrev_b32 v244, 2, v244
    v_mfma_f32_16x16x32_bf16 v[56:59], v[136:139], v[176:179], v[56:59]
    v_mul_f32 v71, s84, v71
    s_waitcnt lgkmcnt(1)
    v_mfma_f32_16x16x32_bf16 v[56:59], v[144:147], v[168:171], v[56:59]
    buffer_load_dwordx4 v[200:203], v2, s[40:43], s21 offen offset:1024 sc0 sc1
    v_mfma_f32_16x16x32_bf16 v[60:63], v[140:143], v[176:179], v[60:63]
    s_lshr_b32 s100, s66, 1
    v_lshlrev_b32 v72, 16, v84
    v_mfma_f32_16x16x32_bf16 v[60:63], v[144:147], v[172:175], v[60:63]
    s_lshl_b32 s100, s100, 8
    v_and_b32 v73, s78, v84
    v_mfma_f32_16x16x32_bf16 v[52:55], v[128:131], v[180:183], v[52:55]
    v_mul_f32 v72, s84, v72
    s_lshl_b32 s94, s60, 4
    v_mfma_f32_16x16x32_bf16 v[52:55], v[148:151], v[160:163], v[52:55]
    buffer_load_dwordx4 v[204:207], v247, s[40:43], s21 offen offset:1024 sc0 sc1
    v_mfma_f32_16x16x32_bf16 v[56:59], v[132:135], v[180:183], v[56:59]
    v_mul_f32 v73, s84, v73
    s_add_u32 s100, s100, s94
    v_mfma_f32_16x16x32_bf16 v[56:59], v[148:151], v[164:167], v[56:59]
    v_lshlrev_b32 v74, 16, v85
    v_and_b32 v75, s78, v85
    v_mfma_f32_16x16x32_bf16 v[60:63], v[136:139], v[180:183], v[60:63]
    s_add_u32 s100, s100, 8192
    v_mul_f32 v74, s84, v74
    v_mfma_f32_16x16x32_bf16 v[60:63], v[148:151], v[168:171], v[60:63]
    buffer_load_dwordx4 v[208:211], v2, s[40:43], s21 offen offset:2048 sc0 sc1
    v_mfma_f32_16x16x32_bf16 v[56:59], v[128:131], v[184:187], v[56:59]
    v_add_u32 v244, s100, v244
    v_mul_f32 v75, s84, v75
    v_mfma_f32_16x16x32_bf16 v[56:59], v[152:155], v[160:163], v[56:59]
    buffer_load_dwordx4 v[212:215], v247, s[40:43], s21 offen offset:2048 sc0 sc1
    buffer_load_dwordx4 v[216:219], v2, s[40:43], s21 offen offset:3072 sc0 sc1
    s_waitcnt lgkmcnt(0)
    buffer_load_dwordx4 v[220:223], v247, s[40:43], s21 offen offset:3072 sc0 sc1
    buffer_load_dword v240, v244, s[40:43], 0 offen sc0 sc1
    buffer_load_dwordx4 v[224:227], v2, s[40:43], s22 offen offset:0 sc0 sc1
    buffer_load_dwordx4 v[228:231], v247, s[40:43], s22 offen offset:0 sc0 sc1
    buffer_load_dwordx4 v[232:235], v2, s[40:43], s22 offen offset:1024 sc0 sc1
    buffer_load_dwordx4 v[236:239], v247, s[40:43], s22 offen offset:1024 sc0 sc1
    v_mfma_f32_16x16x32_bf16 v[60:63], v[132:135], v[184:187], v[60:63]
    v_lshlrev_b32 v76, 16, v86
    v_and_b32 v77, s78, v86
    v_mfma_f32_16x16x32_bf16 v[60:63], v[152:155], v[164:167], v[60:63]
    v_mul_f32 v76, s84, v76
    v_mul_f32 v77, s84, v77
    v_mfma_f32_16x16x32_bf16 v[60:63], v[128:131], v[188:191], v[60:63]
    v_lshlrev_b32 v78, 16, v87
    v_and_b32 v79, s78, v87
    v_mul_f32 v78, s84, v78
    v_mul_f32 v79, s84, v79
    v_mfma_f32_16x16x32_bf16 v[60:63], v[156:159], v[160:163], v[60:63]
    s_nop 5
    s_cmp_eq_u32 s81, 0
    s_cbranch_scc0 L_red_hv1
    ds_write_b128 v6, v[48:51] offset:0
    ds_write_b128 v6, v[52:55] offset:1024
    ds_write_b128 v6, v[56:59] offset:2048
    ds_write_b128 v6, v[60:63] offset:3072
    v_pk_add_f32 v[64:65], v[64:65], v[32:33]
    v_pk_add_f32 v[66:67], v[66:67], v[34:35]
    v_pk_add_f32 v[68:69], v[68:69], v[36:37]
    v_pk_add_f32 v[70:71], v[70:71], v[38:39]
    v_pk_add_f32 v[72:73], v[72:73], v[40:41]
    v_pk_add_f32 v[74:75], v[74:75], v[42:43]
    v_pk_add_f32 v[76:77], v[76:77], v[44:45]
    v_pk_add_f32 v[78:79], v[78:79], v[46:47]
    s_branch L_red_w
L_red_hv1:
    s_nop 0
    ds_write_b128 v6, v[32:35] offset:0
    ds_write_b128 v6, v[36:39] offset:1024
    ds_write_b128 v6, v[40:43] offset:2048
    ds_write_b128 v6, v[44:47] offset:3072
    v_pk_add_f32 v[64:65], v[64:65], v[48:49]
    v_pk_add_f32 v[66:67], v[66:67], v[50:51]
    v_pk_add_f32 v[68:69], v[68:69], v[52:53]
    v_pk_add_f32 v[70:71], v[70:71], v[54:55]
    v_pk_add_f32 v[72:73], v[72:73], v[56:57]
    v_pk_add_f32 v[74:75], v[74:75], v[58:59]
    v_pk_add_f32 v[76:77], v[76:77], v[60:61]
    v_pk_add_f32 v[78:79], v[78:79], v[62:63]
L_red_w:
    s_waitcnt lgkmcnt(0)
    s_barrier
    ds_read_b128 v[96:99], v7 offset:0
    ds_read_b128 v[100:103], v7 offset:1024
    ds_read_b128 v[104:107], v7 offset:2048
    ds_read_b128 v[108:111], v7 offset:3072
    s_waitcnt lgkmcnt(3)
    s_nop 0
    v_pk_add_f32 v[64:65], v[64:65], v[96:97]
    v_pk_add_f32 v[66:67], v[66:67], v[98:99]
    v_cvt_pk_bf16_f32 v112, v64, v65
    v_cvt_pk_bf16_f32 v113, v66, v67
    buffer_store_dwordx2 v[112:113], v245, s[40:43], s70 offen offset:0 sc0 sc1
    s_waitcnt lgkmcnt(2)
    s_nop 0
    v_pk_add_f32 v[68:69], v[68:69], v[100:101]
    v_pk_add_f32 v[70:71], v[70:71], v[102:103]
    v_cvt_pk_bf16_f32 v114, v68, v69
    v_cvt_pk_bf16_f32 v115, v70, v71
    buffer_store_dwordx2 v[114:115], v245, s[40:43], s70 offen offset:512 sc0 sc1
    s_waitcnt lgkmcnt(1)
    s_nop 0
    v_pk_add_f32 v[72:73], v[72:73], v[104:105]
    v_pk_add_f32 v[74:75], v[74:75], v[106:107]
    v_cvt_pk_bf16_f32 v116, v72, v73
    v_cvt_pk_bf16_f32 v117, v74, v75
    buffer_store_dwordx2 v[116:117], v245, s[40:43], s70 offen offset:1024 sc0 sc1
    s_waitcnt lgkmcnt(0)
    s_nop 0
    v_pk_add_f32 v[76:77], v[76:77], v[108:109]
    v_pk_add_f32 v[78:79], v[78:79], v[110:111]
    v_cvt_pk_bf16_f32 v118, v76, v77
    v_cvt_pk_bf16_f32 v119, v78, v79
    buffer_store_dwordx2 v[118:119], v245, s[40:43], s70 offen offset:1536 sc0 sc1
    s_lshl_b32 s71, s61, 8
    s_lshl_b32 s72, s62, 2
    s_add_u32 s71, s71, s72
    s_add_u32 s71, s71, 12288
    s_lshl_b32 s70, s60, 12
    v_add_u32 v6, s70, v2
    s_lshl_b32 s70, s60, 14
    v_add_u32 v3, s70, v2
    s_add_u32 s72, s60, 1
    s_and_b32 s72, s72, 3
    s_lshl_b32 s72, s72, 12
    v_add_u32 v11, s72, v3
    s_add_u32 s72, s60, 2
    s_and_b32 s72, s72, 3
    s_lshl_b32 s72, s72, 12
    v_add_u32 v12, s72, v3
    s_add_u32 s72, s60, 3
    s_and_b32 s72, s72, 3
    s_lshl_b32 s72, s72, 12
    v_add_u32 v13, s72, v3
    s_waitcnt vmcnt(23)
    v_mfma_f32_32x32x16_bf16 v[128:143], a[128:131], a[96:99], 0
    buffer_load_dwordx4 v[32:35], v2, s[40:43], s22 offen offset:2048 sc0 sc1
    buffer_load_dwordx4 v[36:39], v247, s[40:43], s22 offen offset:2048 sc0 sc1
    v_mfma_f32_32x32x16_bf16 v[144:159], a[128:131], a[100:103], 0
    v_mfma_f32_32x32x16_bf16 v[160:175], a[132:135], a[96:99], 0
    buffer_load_dwordx4 v[40:43], v2, s[40:43], s22 offen offset:3072 sc0 sc1
    buffer_load_dwordx4 v[44:47], v247, s[40:43], s22 offen offset:3072 sc0 sc1
    v_mfma_f32_32x32x16_bf16 v[176:191], a[132:135], a[100:103], 0
    s_waitcnt vmcnt(25)
    v_mfma_f32_32x32x16_bf16 v[128:143], a[136:139], a[104:107], v[128:143]
    buffer_load_dwordx4 v[48:51], v2, s[40:43], s23 offen offset:0 sc0 sc1
    buffer_load_dwordx4 v[52:55], v247, s[40:43], s23 offen offset:0 sc0 sc1
    v_mfma_f32_32x32x16_bf16 v[144:159], a[136:139], a[108:111], v[144:159]
    v_mfma_f32_32x32x16_bf16 v[160:175], a[140:143], a[104:107], v[160:175]
    buffer_load_dwordx4 v[56:59], v2, s[40:43], s23 offen offset:1024 sc0 sc1
    buffer_load_dwordx4 v[60:63], v247, s[40:43], s23 offen offset:1024 sc0 sc1
    v_mfma_f32_32x32x16_bf16 v[176:191], a[140:143], a[108:111], v[176:191]
    s_waitcnt vmcnt(27)
    v_mfma_f32_32x32x16_bf16 v[128:143], a[144:147], a[112:115], v[128:143]
    buffer_load_dwordx4 a[128:131], v2, s[40:43], s23 offen offset:2048 sc0 sc1
    buffer_load_dwordx4 a[132:135], v247, s[40:43], s23 offen offset:2048 sc0 sc1
    v_mfma_f32_32x32x16_bf16 v[144:159], a[144:147], a[116:119], v[144:159]
    v_mfma_f32_32x32x16_bf16 v[160:175], a[148:151], a[112:115], v[160:175]
    buffer_load_dwordx4 a[136:139], v2, s[40:43], s23 offen offset:3072 sc0 sc1
    buffer_load_dwordx4 a[140:143], v247, s[40:43], s23 offen offset:3072 sc0 sc1
    v_mfma_f32_32x32x16_bf16 v[176:191], a[148:151], a[116:119], v[176:191]
    s_waitcnt vmcnt(29)
    v_mfma_f32_32x32x16_bf16 v[128:143], a[152:155], a[120:123], v[128:143]
    s_waitcnt vmcnt(20)
    v_cmp_ne_u32 vcc, s68, v240
    s_nop 4
    s_cmp_eq_u64 vcc, 0
    s_cbranch_scc0 L_slow_g2
L_ok_g2:
    buffer_load_dwordx4 a[144:147], v2, s[40:43], s24 offen offset:0 sc0 sc1
    buffer_load_dwordx4 a[148:151], v247, s[40:43], s24 offen offset:0 sc0 sc1
    v_mfma_f32_32x32x16_bf16 v[144:159], a[152:155], a[124:127], v[144:159]
    v_mfma_f32_32x32x16_bf16 v[160:175], a[156:159], a[120:123], v[160:175]
    v_mfma_f32_32x32x16_bf16 v[176:191], a[156:159], a[124:127], v[176:191]
    buffer_load_dwordx4 a[152:155], v2, s[40:43], s24 offen offset:1024 sc0 sc1
    buffer_load_dwordx4 a[156:159], v247, s[40:43], s24 offen offset:1024 sc0 sc1
    v_mfma_f32_32x32x16_bf16 v[128:143], a[160:163], v[192:195], v[128:143]
    v_mfma_f32_32x32x16_bf16 v[144:159], a[160:163], v[196:199], v[144:159]
    v_mfma_f32_32x32x16_bf16 v[160:175], a[164:167], v[192:195], v[160:175]
    s_waitcnt vmcnt(16)
    s_barrier
    v_mfma_f32_32x32x16_bf16 v[176:191], a[164:167], v[196:199], v[176:191]
    buffer_load_dwordx4 a[160:163], v2, s[40:43], s24 offen offset:2048 sc0 sc1
    buffer_load_dwordx4 a[164:167], v247, s[40:43], s24 offen offset:2048 sc0 sc1
    s_add_u32 s99, s71, s69
    v_mov_b32 v254, s99
    v_mov_b32 v255, s68
    s_mov_b64 exec, 1
    buffer_store_dword v255, v254, s[40:43], 0 offen sc0 sc1
    s_mov_b64 exec, -1
    v_mfma_f32_32x32x16_bf16 v[128:143], a[168:171], v[200:203], v[128:143]
    v_mfma_f32_32x32x16_bf16 v[144:159], a[168:171], v[204:207], v[144:159]
    v_mfma_f32_32x32x16_bf16 v[160:175], a[172:175], v[200:203], v[160:175]
    v_mfma_f32_32x32x16_bf16 v[176:191], a[172:175], v[204:207], v[176:191]
    buffer_load_dwordx4 a[168:171], v2, s[40:43], s24 offen offset:3072 sc0 sc1
    buffer_load_dwordx4 a[172:175], v247, s[40:43], s24 offen offset:3072 sc0 sc1
    v_mfma_f32_32x32x16_bf16 v[128:143], a[176:179], v[208:211], v[128:143]
    v_mfma_f32_32x32x16_bf16 v[144:159], a[176:179], v[212:215], v[144:159]
    v_mfma_f32_32x32x16_bf16 v[160:175], a[180:183], v[208:211], v[160:175]
    v_mfma_f32_32x32x16_bf16 v[176:191], a[180:183], v[212:215], v[176:191]
    buffer_load_dwordx4 a[176:179], v2, s[40:43], s25 offen offset:0 sc0 sc1
    buffer_load_dwordx4 a[180:183], v247, s[40:43], s25 offen offset:0 sc0 sc1
    v_mfma_f32_32x32x16_bf16 v[128:143], a[184:187], v[216:219], v[128:143]
    v_mfma_f32_32x32x16_bf16 v[144:159], a[184:187], v[220:223], v[144:159]
    v_mfma_f32_32x32x16_bf16 v[160:175], a[188:191], v[216:219], v[160:175]
    v_mfma_f32_32x32x16_bf16 v[176:191], a[188:191], v[220:223], v[176:191]
    buffer_load_dwordx4 a[184:187], v2, s[40:43], s25 offen offset:1024 sc0 sc1
    buffer_load_dwordx4 a[188:191], v247, s[40:43], s25 offen offset:1024 sc0 sc1
    v_mfma_f32_32x32x16_bf16 v[128:143], a[192:195], v[224:227], v[128:143]
    v_mfma_f32_32x32x16_bf16 v[144:159], a[192:195], v[228:231], v[144:159]
    v_mfma_f32_32x32x16_bf16 v[160:175], a[196:199], v[224:227], v[160:175]
    v_mfma_f32_32x32x16_bf16 v[176:191], a[196:199], v[228:231], v[176:191]
    buffer_load_dwordx4 a[192:195], v2, s[40:43], s25 offen offset:2048 sc0 sc1
    buffer_load_dwordx4 a[196:199], v247, s[40:43], s25 offen offset:2048 sc0 sc1
    v_mfma_f32_32x32x16_bf16 v[128:143], a[200:203], v[232:235], v[128:143]
    v_mfma_f32_32x32x16_bf16 v[144:159], a[200:203], v[236:239], v[144:159]
    v_mfma_f32_32x32x16_bf16 v[160:175], a[204:207], v[232:235], v[160:175]
    v_mfma_f32_32x32x16_bf16 v[176:191], a[204:207], v[236:239], v[176:191]
    buffer_load_dwordx4 a[200:203], v2, s[40:43], s25 offen offset:3072 sc0 sc1
    buffer_load_dwordx4 a[204:207], v247, s[40:43], s25 offen offset:3072 sc0 sc1
    s_waitcnt vmcnt(27)
    v_mfma_f32_32x32x16_bf16 v[128:143], a[208:211], v[32:35], v[128:143]
    v_mfma_f32_32x32x16_bf16 v[144:159], a[208:211], v[36:39], v[144:159]
    buffer_load_dwordx2 v[80:81], v30, s[36:39], s93 offen offset:0
    v_mfma_f32_32x32x16_bf16 v[160:175], a[212:215], v[32:35], v[160:175]
    v_mfma_f32_32x32x16_bf16 v[176:191], a[212:215], v[36:39], v[176:191]
    buffer_load_dwordx4 a[208:211], v2, s[40:43], s26 offen offset:0 sc0 sc1
    buffer_load_dwordx4 a[212:215], v247, s[40:43], s26 offen offset:0 sc0 sc1
    s_waitcnt vmcnt(28)
    v_mfma_f32_32x32x16_bf16 v[128:143], a[216:219], v[40:43], v[128:143]
    v_mfma_f32_32x32x16_bf16 v[144:159], a[216:219], v[44:47], v[144:159]
    buffer_load_dwordx2 v[82:83], v30, s[36:39], s93 offen offset:16
    v_mfma_f32_32x32x16_bf16 v[160:175], a[220:223], v[40:43], v[160:175]
    v_mfma_f32_32x32x16_bf16 v[176:191], a[220:223], v[44:47], v[176:191]
    buffer_load_dwordx4 a[216:219], v2, s[40:43], s26 offen offset:1024 sc0 sc1
    buffer_load_dwordx4 a[220:223], v247, s[40:43], s26 offen offset:1024 sc0 sc1
    s_waitcnt vmcnt(29)
    v_mfma_f32_32x32x16_bf16 v[128:143], a[224:227], v[48:51], v[128:143]
    v_mfma_f32_32x32x16_bf16 v[144:159], a[224:227], v[52:55], v[144:159]
    buffer_load_dwordx2 v[84:85], v30, s[36:39], s93 offen offset:32
    v_mfma_f32_32x32x16_bf16 v[160:175], a[228:231], v[48:51], v[160:175]
    v_mfma_f32_32x32x16_bf16 v[176:191], a[228:231], v[52:55], v[176:191]
    buffer_load_dwordx4 a[224:227], v2, s[40:43], s26 offen offset:2048 sc0 sc1
    buffer_load_dwordx4 a[228:231], v247, s[40:43], s26 offen offset:2048 sc0 sc1
    s_waitcnt vmcnt(30)
    v_mfma_f32_32x32x16_bf16 v[128:143], a[232:235], v[56:59], v[128:143]
    v_mfma_f32_32x32x16_bf16 v[144:159], a[232:235], v[60:63], v[144:159]
    buffer_load_dwordx2 v[86:87], v30, s[36:39], s93 offen offset:48
    v_mfma_f32_32x32x16_bf16 v[160:175], a[236:239], v[56:59], v[160:175]
    v_mfma_f32_32x32x16_bf16 v[176:191], a[236:239], v[60:63], v[176:191]
    buffer_load_dwordx4 a[232:235], v2, s[40:43], s26 offen offset:3072 sc0 sc1
    buffer_load_dwordx4 a[236:239], v247, s[40:43], s26 offen offset:3072 sc0 sc1
    s_waitcnt vmcnt(31)
    v_mfma_f32_32x32x16_bf16 v[128:143], a[240:243], a[128:131], v[128:143]
    v_mfma_f32_32x32x16_bf16 v[144:159], a[240:243], a[132:135], v[144:159]
    v_mfma_f32_32x32x16_bf16 v[160:175], a[244:247], a[128:131], v[160:175]
    v_mfma_f32_32x32x16_bf16 v[176:191], a[244:247], a[132:135], v[176:191]
    s_waitcnt vmcnt(29)
    v_mfma_f32_32x32x16_bf16 v[128:143], a[248:251], a[136:139], v[128:143]
    v_mfma_f32_32x32x16_bf16 v[144:159], a[248:251], a[140:143], v[144:159]
    v_mfma_f32_32x32x16_bf16 v[160:175], a[252:255], a[136:139], v[160:175]
    v_mfma_f32_32x32x16_bf16 v[176:191], a[252:255], a[140:143], v[176:191]
    s_waitcnt vmcnt(27)
    v_mfma_f32_32x32x16_bf16 v[128:143], a[0:3], a[144:147], v[128:143]
    v_mfma_f32_32x32x16_bf16 v[144:159], a[0:3], a[148:151], v[144:159]
    v_mfma_f32_32x32x16_bf16 v[160:175], a[4:7], a[144:147], v[160:175]
    v_mfma_f32_32x32x16_bf16 v[176:191], a[4:7], a[148:151], v[176:191]
    s_waitcnt vmcnt(25)
    v_mfma_f32_32x32x16_bf16 v[128:143], a[8:11], a[152:155], v[128:143]
    v_mfma_f32_32x32x16_bf16 v[144:159], a[8:11], a[156:159], v[144:159]
    v_mfma_f32_32x32x16_bf16 v[160:175], a[12:15], a[152:155], v[160:175]
    v_mfma_f32_32x32x16_bf16 v[176:191], a[12:15], a[156:159], v[176:191]
    s_waitcnt vmcnt(23)
    v_mfma_f32_32x32x16_bf16 v[128:143], a[16:19], a[160:163], v[128:143]
    v_mfma_f32_32x32x16_bf16 v[144:159], a[16:19], a[164:167], v[144:159]
    v_mfma_f32_32x32x16_bf16 v[160:175], a[20:23], a[160:163], v[160:175]
    v_mfma_f32_32x32x16_bf16 v[176:191], a[20:23], a[164:167], v[176:191]
    s_waitcnt vmcnt(20)
    v_mfma_f32_32x32x16_bf16 v[128:143], a[24:27], a[168:171], v[128:143]
    v_mfma_f32_32x32x16_bf16 v[144:159], a[24:27], a[172:175], v[144:159]
    v_mfma_f32_32x32x16_bf16 v[160:175], a[28:31], a[168:171], v[160:175]
    v_mfma_f32_32x32x16_bf16 v[176:191], a[28:31], a[172:175], v[176:191]
    s_waitcnt vmcnt(18)
    v_mfma_f32_32x32x16_bf16 v[128:143], a[32:35], a[176:179], v[128:143]
    v_mfma_f32_32x32x16_bf16 v[144:159], a[32:35], a[180:183], v[144:159]
    v_mfma_f32_32x32x16_bf16 v[160:175], a[36:39], a[176:179], v[160:175]
    v_mfma_f32_32x32x16_bf16 v[176:191], a[36:39], a[180:183], v[176:191]
    s_waitcnt vmcnt(16)
    v_mfma_f32_32x32x16_bf16 v[128:143], a[40:43], a[184:187], v[128:143]
    v_and_b32 v244, 15, v1
    v_lshlrev_b32 v244, 2, v244
    v_mfma_f32_32x32x16_bf16 v[144:159], a[40:43], a[188:191], v[144:159]
    s_lshl_b32 s100, s67, 8
    v_mfma_f32_32x32x16_bf16 v[160:175], a[44:47], a[184:187], v[160:175]
    s_add_u32 s100, s100, 12288
    v_mfma_f32_32x32x16_bf16 v[176:191], a[44:47], a[188:191], v[176:191]
    s_lshl_b32 s94, s82, 6
    s_add_u32 s100, s100, s94
    s_waitcnt vmcnt(14)
    v_mfma_f32_32x32x16_bf16 v[128:143], a[48:51], a[192:195], v[128:143]
    v_add_u32 v244, s100, v244
    v_mfma_f32_32x32x16_bf16 v[144:159], a[48:51], a[196:199], v[144:159]
    buffer_load_dword v240, v244, s[40:43], 0 offen sc0 sc1
    v_mfma_f32_32x32x16_bf16 v[160:175], a[52:55], a[192:195], v[160:175]
    v_mfma_f32_32x32x16_bf16 v[176:191], a[52:55], a[196:199], v[176:191]
    s_waitcnt vmcnt(13)
    v_mfma_f32_32x32x16_bf16 v[128:143], a[56:59], a[200:203], v[128:143]
    v_mfma_f32_32x32x16_bf16 v[144:159], a[56:59], a[204:207], v[144:159]
    v_mfma_f32_32x32x16_bf16 v[160:175], a[60:63], a[200:203], v[160:175]
    v_mfma_f32_32x32x16_bf16 v[176:191], a[60:63], a[204:207], v[176:191]
    s_waitcnt vmcnt(10)
    v_mfma_f32_32x32x16_bf16 v[128:143], a[64:67], a[208:211], v[128:143]
    s_waitcnt vmcnt(7)
    v_mfma_f32_32x32x16_bf16 v[128:143], a[72:75], a[216:219], v[128:143]
    s_waitcnt vmcnt(4)
    v_mfma_f32_32x32x16_bf16 v[128:143], a[80:83], a[224:227], v[128:143]
    s_waitcnt vmcnt(1)
    v_mfma_f32_32x32x16_bf16 v[128:143], a[88:91], a[232:235], v[128:143]
    v_mfma_f32_32x32x16_bf16 v[144:159], a[64:67], a[212:215], v[144:159]
    s_waitcnt vmcnt(0)
    v_cmp_ne_u32 vcc, s68, v240
    s_nop 4
    s_cmp_eq_u64 vcc, 0
    s_cbranch_scc0 L_slow_g3
L_ok_g3:
    s_lshl_b32 s99, s67, 6
    v_mfma_f32_32x32x16_bf16 v[144:159], a[72:75], a[220:223], v[144:159]
    s_lshl_b32 s100, s82, 5
    s_add_u32 s99, s99, s100
    v_mfma_f32_32x32x16_bf16 v[144:159], a[80:83], a[228:231], v[144:159]
    s_lshl_b32 s99, s99, 12
    v_mfma_f32_32x32x16_bf16 v[144:159], a[88:91], a[236:239], v[144:159]
    s_nop 5
    s_cmp_eq_u32 s60, 0
    s_cbranch_scc1 L_own0
    ds_write_b128 v6, v[128:131] offset:0
    ds_write_b128 v6, v[132:135] offset:1024
    ds_write_b128 v6, v[136:139] offset:2048
    ds_write_b128 v6, v[140:143] offset:3072
L_own0:
    v_mfma_f32_32x32x16_bf16 v[160:175], a[68:71], a[208:211], v[160:175]
    s_lshl_b32 s100, s66, 7
    s_add_u32 s99, s99, s100
    v_mfma_f32_32x32x16_bf16 v[160:175], a[76:79], a[216:219], v[160:175]
    s_lshl_b32 s100, s81, 6
    v_mfma_f32_32x32x16_bf16 v[160:175], a[84:87], a[224:227], v[160:175]
    s_add_u32 s99, s99, s100
    v_mfma_f32_32x32x16_bf16 v[160:175], a[92:95], a[232:235], v[160:175]
    s_nop 5
    s_cmp_eq_u32 s60, 1
    s_cbranch_scc1 L_own1
    ds_write_b128 v6, v[144:147] offset:16384
    ds_write_b128 v6, v[148:151] offset:17408
    ds_write_b128 v6, v[152:155] offset:18432
    ds_write_b128 v6, v[156:159] offset:19456
L_own1:
    v_mfma_f32_32x32x16_bf16 v[176:191], a[68:71], a[212:215], v[176:191]
    s_add_u32 s99, s99, 13631488
    s_add_u32 s100, s99, 65536
    v_mfma_f32_32x32x16_bf16 v[176:191], a[76:79], a[220:223], v[176:191]
    buffer_load_dwordx4 v[64:67], v31, s[40:43], s99 offen sc0 sc1
    v_mfma_f32_32x32x16_bf16 v[176:191], a[84:87], a[228:231], v[176:191]
    buffer_load_dwordx4 v[68:71], v31, s[40:43], s100 offen sc0 sc1
    v_mfma_f32_32x32x16_bf16 v[176:191], a[92:95], a[236:239], v[176:191]
    s_nop 5
    s_cmp_eq_u32 s60, 2
    s_cbranch_scc1 L_own2
    ds_write_b128 v6, v[160:163] offset:32768
    ds_write_b128 v6, v[164:167] offset:33792
    ds_write_b128 v6, v[168:171] offset:34816
    s_nop 0
    ds_write_b128 v6, v[172:175] offset:35840
L_own2:
    s_nop 7
    s_nop 3
    s_cmp_eq_u32 s60, 3
    s_cbranch_scc1 L_own3
    ds_write_b128 v6, v[176:179] offset:49152
    ds_write_b128 v6, v[180:183] offset:50176
    ds_write_b128 v6, v[184:187] offset:51200
    ds_write_b128 v6, v[188:191] offset:52224
L_own3:
    s_cmp_lg_u32 s60, 0
    s_cbranch_scc1 L_notme0
    v_pk_mov_b32 v[112:113], v[128:129], v[128:129] op_sel:[0,1]
    v_pk_mov_b32 v[114:115], v[130:131], v[130:131] op_sel:[0,1]
    v_pk_mov_b32 v[116:117], v[132:133], v[132:133] op_sel:[0,1]
    v_pk_mov_b32 v[118:119], v[134:135], v[134:135] op_sel:[0,1]
    v_pk_mov_b32 v[120:121], v[136:137], v[136:137] op_sel:[0,1]
    v_pk_mov_b32 v[122:123], v[138:139], v[138:139] op_sel:[0,1]
    v_pk_mov_b32 v[124:125], v[140:141], v[140:141] op_sel:[0,1]
    v_pk_mov_b32 v[126:127], v[142:143], v[142:143] op_sel:[0,1]
    s_branch L_wdone
L_notme0:
    s_cmp_lg_u32 s60, 1
    s_cbranch_scc1 L_notme1
    s_nop 0
    v_pk_mov_b32 v[112:113], v[144:145], v[144:145] op_sel:[0,1]
    v_pk_mov_b32 v[114:115], v[146:147], v[146:147] op_sel:[0,1]
    v_pk_mov_b32 v[116:117], v[148:149], v[148:149] op_sel:[0,1]
    v_pk_mov_b32 v[118:119], v[150:151], v[150:151] op_sel:[0,1]
    v_pk_mov_b32 v[120:121], v[152:153], v[152:153] op_sel:[0,1]
    v_pk_mov_b32 v[122:123], v[154:155], v[154:155] op_sel:[0,1]
    v_pk_mov_b32 v[124:125], v[156:157], v[156:157] op_sel:[0,1]
    v_pk_mov_b32 v[126:127], v[158:159], v[158:159] op_sel:[0,1]
    s_branch L_wdone
L_notme1:
    s_cmp_lg_u32 s60, 2
    s_cbranch_scc1 L_notme2
    s_nop 0
    v_pk_mov_b32 v[112:113], v[160:161], v[160:161] op_sel:[0,1]
    v_pk_mov_b32 v[114:115], v[162:163], v[162:163] op_sel:[0,1]
    v_pk_mov_b32 v[116:117], v[164:165], v[164:165] op_sel:[0,1]
    v_pk_mov_b32 v[118:119], v[166:167], v[166:167] op_sel:[0,1]
    v_pk_mov_b32 v[120:121], v[168:169], v[168:169] op_sel:[0,1]
    v_pk_mov_b32 v[122:123], v[170:171], v[170:171] op_sel:[0,1]
    v_pk_mov_b32 v[124:125], v[172:173], v[172:173] op_sel:[0,1]
    v_pk_mov_b32 v[126:127], v[174:175], v[174:175] op_sel:[0,1]
    s_branch L_wdone
L_notme2:
    s_cmp_lg_u32 s60, 3
    s_cbranch_scc1 L_notme3
    s_nop 0
    v_pk_mov_b32 v[112:113], v[176:177], v[176:177] op_sel:[0,1]
    v_pk_mov_b32 v[114:115], v[178:179], v[178:179] op_sel:[0,1]
    v_pk_mov_b32 v[116:117], v[180:181], v[180:181] op_sel:[0,1]
    v_pk_mov_b32 v[118:119], v[182:183], v[182:183] op_sel:[0,1]
    v_pk_mov_b32 v[120:121], v[184:185], v[184:185] op_sel:[0,1]
    v_pk_mov_b32 v[122:123], v[186:187], v[186:187] op_sel:[0,1]
    v_pk_mov_b32 v[124:125], v[188:189], v[188:189] op_sel:[0,1]
    v_pk_mov_b32 v[126:127], v[190:191], v[190:191] op_sel:[0,1]
L_notme3:
L_wdone:
    s_waitcnt lgkmcnt(0)
    s_barrier
    ds_read_b128 v[192:195], v11 offset:0
    ds_read_b128 v[196:199], v11 offset:1024
    ds_read_b128 v[200:203], v11 offset:2048
    ds_read_b128 v[204:207], v11 offset:3072
    ds_read_b128 v[208:211], v12 offset:0
    ds_read_b128 v[212:215], v12 offset:1024
    ds_read_b128 v[216:219], v12 offset:2048
    ds_read_b128 v[220:223], v12 offset:3072
    ds_read_b128 v[224:227], v13 offset:0
    ds_read_b128 v[228:231], v13 offset:1024
    ds_read_b128 v[232:235], v13 offset:2048
    ds_read_b128 v[236:239], v13 offset:3072
    s_waitcnt vmcnt(0)
    s_nop 0
    ds_write_b128 v248, v[64:67]
    ds_write_b128 v248, v[68:71] offset:1024
    v_lshlrev_b32 v96, 16, v80
    v_and_b32 v97, s78, v80
    v_lshlrev_b32 v98, 16, v81
    v_and_b32 v99, s78, v81
    v_lshlrev_b32 v100, 16, v82
    v_and_b32 v101, s78, v82
    v_lshlrev_b32 v102, 16, v83
    v_and_b32 v103, s78, v83
    v_lshlrev_b32 v104, 16, v84
    v_and_b32 v105, s78, v84
    v_lshlrev_b32 v106, 16, v85
    v_and_b32 v107, s78, v85
    v_lshlrev_b32 v108, 16, v86
    v_and_b32 v109, s78, v86
    v_lshlrev_b32 v110, 16, v87
    v_and_b32_e64 v111, s78, v87
    s_waitcnt lgkmcnt(0)
    ds_read_b64_tr_b16 v[72:73], v249 offset:0
    ds_read_b64_tr_b16 v[74:75], v249 offset:512
    ds_read_b64_tr_b16 v[76:77], v249 offset:1024
    ds_read_b64_tr_b16 v[78:79], v249 offset:1536
    s_waitcnt lgkmcnt(3)
    v_lshlrev_b32 v8, 16, v72
    v_and_b32 v9, s78, v72
    v_add_f32 v96, v96, v8
    v_add_f32 v97, v97, v9
    v_lshlrev_b32 v8, 16, v73
    v_and_b32 v9, s78, v73
    v_add_f32 v98, v98, v8
    v_add_f32 v99, v99, v9
    s_waitcnt lgkmcnt(2)
    v_lshlrev_b32 v8, 16, v74
    v_and_b32 v9, s78, v74
    v_add_f32 v100, v100, v8
    v_add_f32 v101, v101, v9
    v_lshlrev_b32 v8, 16, v75
    v_and_b32 v9, s78, v75
    v_add_f32 v102, v102, v8
    v_add_f32 v103, v103, v9
    s_waitcnt lgkmcnt(1)
    v_lshlrev_b32 v8, 16, v76
    v_and_b32 v9, s78, v76
    v_add_f32 v104, v104, v8
    v_add_f32 v105, v105, v9
    v_lshlrev_b32 v8, 16, v77
    v_and_b32 v9, s78, v77
    v_add_f32 v106, v106, v8
    v_add_f32 v107, v107, v9
    s_waitcnt lgkmcnt(0)
    v_lshlrev_b32 v8, 16, v78
    v_and_b32 v9, s78, v78
    v_add_f32 v108, v108, v8
    v_add_f32 v109, v109, v9
    v_lshlrev_b32 v8, 16, v79
    v_and_b32 v9, s78, v79
    v_add_f32 v110, v110, v8
    v_add_f32 v111, v111, v9
    v_pk_add_f32 v[112:113], v[112:113], v[192:193]
    v_pk_add_f32 v[114:115], v[114:115], v[194:195]
    v_pk_add_f32 v[116:117], v[116:117], v[196:197]
    v_pk_add_f32 v[118:119], v[118:119], v[198:199]
    v_pk_add_f32 v[120:121], v[120:121], v[200:201]
    v_pk_add_f32 v[122:123], v[122:123], v[202:203]
    v_pk_add_f32 v[124:125], v[124:125], v[204:205]
    v_pk_add_f32 v[126:127], v[126:127], v[206:207]
    v_pk_add_f32 v[112:113], v[112:113], v[208:209]
    v_pk_add_f32 v[114:115], v[114:115], v[210:211]
    v_pk_add_f32 v[116:117], v[116:117], v[212:213]
    v_pk_add_f32 v[118:119], v[118:119], v[214:215]
    v_pk_add_f32 v[120:121], v[120:121], v[216:217]
    v_pk_add_f32 v[122:123], v[122:123], v[218:219]
    v_pk_add_f32 v[124:125], v[124:125], v[220:221]
    v_pk_add_f32 v[126:127], v[126:127], v[222:223]
    v_pk_add_f32 v[112:113], v[112:113], v[224:225]
    v_pk_add_f32 v[114:115], v[114:115], v[226:227]
    v_pk_add_f32 v[116:117], v[116:117], v[228:229]
    v_pk_add_f32 v[118:119], v[118:119], v[230:231]
    v_pk_add_f32 v[120:121], v[120:121], v[232:233]
    v_pk_add_f32 v[122:123], v[122:123], v[234:235]
    v_pk_add_f32 v[124:125], v[124:125], v[236:237]
    v_pk_add_f32 v[126:127], v[126:127], v[238:239]
    v_pk_add_f32 v[96:97], v[96:97], v[112:113]
    v_pk_add_f32 v[98:99], v[98:99], v[114:115]
    v_pk_add_f32 v[100:101], v[100:101], v[116:117]
    v_pk_add_f32 v[102:103], v[102:103], v[118:119]
    v_pk_add_f32 v[104:105], v[104:105], v[120:121]
    v_pk_add_f32 v[106:107], v[106:107], v[122:123]
    v_pk_add_f32 v[108:109], v[108:109], v[124:125]
    v_pk_add_f32 v[110:111], v[110:111], v[126:127]
    v_cvt_pk_bf16_f32 v16, v96, v97
    v_cvt_pk_bf16_f32 v17, v98, v99
    buffer_store_dwordx2 v[16:17], v30, s[56:59], s93 offen offset:0
    v_cvt_pk_bf16_f32 v18, v100, v101
    v_cvt_pk_bf16_f32 v19, v102, v103
    buffer_store_dwordx2 v[18:19], v30, s[56:59], s93 offen offset:16
    v_cvt_pk_bf16_f32 v20, v104, v105
    v_cvt_pk_bf16_f32 v21, v106, v107
    buffer_store_dwordx2 v[20:21], v30, s[56:59], s93 offen offset:32
    v_cvt_pk_bf16_f32 v22, v108, v109
    v_cvt_pk_bf16_f32 v23, v110, v111
    buffer_store_dwordx2 v[22:23], v30, s[56:59], s93 offen offset:48
L_end:
    s_endpgm
L_slow_g1:
    s_mov_b32 s94, 0
L_spin_g1:
    s_sleep 1
    buffer_load_dword v240, v244, s[40:43], 0 offen sc0 sc1
    s_waitcnt vmcnt(0)
    v_cmp_ne_u32 vcc, s68, v240
    s_nop 4
    s_cmp_eq_u64 vcc, 0
    s_cbranch_scc1 L_ok_g1
    s_add_u32 s94, s94, 1
    s_cmp_lt_u32 s94, 200000
    s_cbranch_scc1 L_spin_g1
    s_branch L_ok_g1
L_slow_c1:
    s_mov_b32 s94, 0
L_spin_c1:
    s_sleep 1
    buffer_load_dwordx4 v[240:243], v244, s[40:43], 0 offen sc0 sc1
    s_waitcnt vmcnt(0)
    v_xor_b32 v240, s68, v240
    v_xor_b32 v241, s68, v241
    v_xor_b32 v242, s68, v242
    v_xor_b32 v243, s68, v243
    v_or_b32_e64 v240, v240, v241
    v_or3_b32 v240, v240, v242, v243
    v_cmp_ne_u32 vcc, 0, v240
    s_nop 4
    s_cmp_eq_u64 vcc, 0
    s_cbranch_scc1 L_ok_c1
    s_add_u32 s94, s94, 1
    s_cmp_lt_u32 s94, 200000
    s_cbranch_scc1 L_spin_c1
    s_branch L_ok_c1
L_slow_g2a:
    s_mov_b32 s94, 0
L_spin_g2a:
    s_sleep 1
    buffer_load_dword v240, v244, s[40:43], 0 offen sc0 sc1
    s_waitcnt vmcnt(0)
    v_cmp_ne_u32 vcc, s68, v240
    s_nop 4
    s_cmp_eq_u64 vcc, 0
    s_cbranch_scc1 L_ok_g2a
    s_add_u32 s94, s94, 1
    s_cmp_lt_u32 s94, 200000
    s_cbranch_scc1 L_spin_g2a
    s_branch L_ok_g2a
L_slow_g2:
    s_mov_b32 s94, 0
L_spin_g2:
    s_sleep 1
    buffer_load_dword v240, v244, s[40:43], 0 offen sc0 sc1
    s_waitcnt vmcnt(0)
    v_cmp_ne_u32 vcc, s68, v240
    s_nop 4
    s_cmp_eq_u64 vcc, 0
    s_cbranch_scc1 L_ok_g2
    s_add_u32 s94, s94, 1
    s_cmp_lt_u32 s94, 200000
    s_cbranch_scc1 L_spin_g2
    s_branch L_ok_g2
L_slow_g3:
    s_mov_b32 s94, 0
L_spin_g3:
    s_sleep 1
    buffer_load_dword v240, v244, s[40:43], 0 offen sc0 sc1
    s_waitcnt vmcnt(0)
    v_cmp_ne_u32 vcc, s68, v240
    s_nop 4
    s_cmp_eq_u64 vcc, 0
    s_cbranch_scc1 L_ok_g3
    s_add_u32 s94, s94, 1
    s_cmp_lt_u32 s94, 200000
    s_cbranch_scc1 L_spin_g3
    s_branch L_ok_g3
.section .rodata,"a"
.p2align 6
.amdhsa_kernel parallel_sum__ssm_conv_s4__glu_gated_geglu__prompt_kernel
  .amdhsa_next_free_vgpr 512
  .amdhsa_next_free_sgpr 102
  .amdhsa_accum_offset 256
  .amdhsa_group_segment_fixed_size 0
  .amdhsa_kernarg_size 128
  .amdhsa_user_sgpr_count 2
  .amdhsa_user_sgpr_kernarg_segment_ptr 1
  .amdhsa_system_sgpr_workgroup_id_x 1
.end_amdhsa_kernel
```
